```python
import torch

def _softmax(x, axis=-1):
    return torch.softmax(x, dim=axis)
def _gelu(x):
    return torch.nn.functional.gelu(x, approximate="tanh")
def _silu(x):
    return torch.nn.functional.silu(x)
def _sigmoid(x):
    return torch.sigmoid(x)
def _layernorm(x, axis=-1, eps=1e-5):
    m = x.mean(dim=axis, keepdim=True)
    v = x.var(dim=axis, keepdim=True, unbiased=False)
    return (x - m) / torch.sqrt(v + eps)
def _scatter_add(tgt, idx, src, axis=0):
    return tgt.clone().index_add_(axis, idx, src)
def _segment_sum(src, seg, n):
    out = torch.zeros((n,) + src.shape[1:], dtype=src.dtype)
    return out.index_add_(0, seg, src)
def _pad(x, pw):
    flat = tuple(v for pair in reversed(pw) for v in pair)
    return torch.nn.functional.pad(x, flat)

kernel_name = 'parallel_sum__linear_kernel_hedgehog__dense_activation_squared_relu__prompt'

def setup_inputs():

    _w = (lambda a: (lambda t: t.to(torch.bfloat16) if t.is_floating_point() else t)(torch.as_tensor(a)))
    def _A_setup():
        B, S, D, H = 1, 2048, 512, 32
        Dh = D // H
        return {
            "x": _w((lambda *s: torch.randn(*s, dtype=torch.bfloat16) * 0.05)(B, S, D)),
            "wqkv": _w((lambda *s: torch.randn(*s, dtype=torch.bfloat16) * 0.8)(D, 3 * D)),
            "w_phi": _w((lambda *s: torch.randn(*s, dtype=torch.bfloat16) * 0.8)(H, Dh, Dh) * (Dh ** -0.5)),
            "wo": _w((lambda *s: torch.randn(*s, dtype=torch.bfloat16) * 0.2)(D, D)),
        }
    _A_in = _A_setup()

    def _B_setup():
        B, S, D, F = 1, 2048, 512, 1792
        return {
            "x": _w((lambda *s: torch.randn(*s, dtype=torch.bfloat16) * 0.05)(B, S, D)),
            "w1": _w((lambda *s: torch.randn(*s, dtype=torch.bfloat16) * 0.05)(D, F)),
            "b1": _w((lambda *s: torch.randn(*s, dtype=torch.bfloat16) * 0.4)(F)),
            "w2": _w((lambda *s: torch.randn(*s, dtype=torch.bfloat16) * 0.05)(F, D)),
            "b2": _w((lambda *s: torch.randn(*s, dtype=torch.bfloat16) * 3.2)(D)),
        }
    _B_in = _B_setup()

    return {
        "A_x": _A_in["x"],
        "A_wqkv": _A_in["wqkv"],
        "A_w_phi": _A_in["w_phi"],
        "A_wo": _A_in["wo"],
        "B_x": _B_in["x"],
        "B_w1": _B_in["w1"],
        "B_b1": _B_in["b1"],
        "B_w2": _B_in["w2"],
        "B_b2": _B_in["b2"],
    }

def reference(A_x, A_wqkv, A_w_phi, A_wo, B_x, B_w1, B_b1, B_w2, B_b2):
    def _A_ref(x, wqkv, w_phi, wo):
        B, S, D = x.shape
        H = 32; Dh = D // H
        qkv = (lambda x, *d: x.permute(*d))((x @ wqkv).reshape(B, S, 3, H, Dh), 2, 0, 3, 1, 4)
        q, k, v = qkv[0], qkv[1], qkv[2]
        pq = torch.einsum("bhsd,hdf->bhsf", q, w_phi)
        pk = torch.einsum("bhsd,hdf->bhsf", k, w_phi)
        phi_q = torch.concatenate([_softmax(pq, axis=-1), _softmax(-pq, axis=-1)], axis=-1)
        phi_k = torch.concatenate([_softmax(pk, axis=-1), _softmax(-pk, axis=-1)], axis=-1)
        kv = torch.einsum("bhsf,bhsd->bhfd", phi_k, v)
        z  = torch.einsum("bhsf->bhf", phi_k)
        num = torch.einsum("bhqf,bhfd->bhqd", phi_q, kv)
        den = torch.einsum("bhqf,bhf->bhq", phi_q, z)[..., None] + 1e-6
        o = num / den
        return (lambda x, *d: x.permute(*d))(o, 0, 2, 1, 3).reshape(B, S, D) @ wo

    def _B_ref(x, w1, b1, w2, b2):
        h = torch.einsum("bsd,df->bsf", x, w1) + b1
        zero = torch.zeros_like(h)
        r = torch.where(h > zero, h, zero)
        h = r * r
        out = torch.einsum("bsf,fd->bsd", h, w2) + b2
        return out

    x = A_x
    xn = _layernorm(x, axis=-1)
    return x + _A_ref(xn, A_wqkv, A_w_phi, A_wo) + _B_ref(xn, B_w1, B_b1, B_w2, B_b2)
```

```asm
; @launch grid=(256,1,1) block=(512,1,1) lds=163840
.amdgcn_target "amdgcn-amd-amdhsa--gfx950"
.text
.globl parallel_sum__linear_kernel_hedgehog__dense_activation_squared_relu__prompt_kernel
.p2align 8
.type parallel_sum__linear_kernel_hedgehog__dense_activation_squared_relu__prompt_kernel,@function
parallel_sum__linear_kernel_hedgehog__dense_activation_squared_relu__prompt_kernel:
    s_cmp_ge_u32 s2, 256
    s_cbranch_scc1 L_end
    s_load_dwordx2 s[12:13], s[0:1], 0
    s_load_dwordx2 s[16:17], s[0:1], 8
    s_load_dwordx2 s[20:21], s[0:1], 40
    s_load_dwordx2 s[24:25], s[0:1], 88
    s_load_dwordx2 s[28:29], s[0:1], 80
    s_load_dwordx2 s[32:33], s[0:1], 16
    s_load_dwordx2 s[36:37], s[0:1], 48
    s_load_dwordx2 s[44:45], s[0:1], 56
    s_load_dwordx2 s[48:49], s[0:1], 24
    s_load_dwordx2 s[52:53], s[0:1], 64
    s_load_dwordx2 s[56:57], s[0:1], 72
    v_and_b32 v1, 63, v0
    v_lshrrev_b32 v2, 6, v0
    s_nop 0
    v_readfirstlane_b32 s3, v2
    s_bfe_u32 s4, s2, 0x30003
    s_bfe_u32 s9, s2, 0x10002
    s_lshl_b32 s9, s9, 3
    s_add_u32 s4, s4, s9
    s_lshr_b32 s5, s2, 7
    s_and_b32 s6, s2, 3
    s_lshl_b32 s6, s6, 1
    s_bfe_u32 s10, s2, 0x10006
    s_add_u32 s6, s6, s10
    v_lshrrev_b32 v9, 3, v1
    v_and_b32 v10, 7, v1
    v_lshrrev_b32 v11, 4, v1
    v_xor_b32 v12, v10, v11
    v_lshlrev_b32 v13, 10, v9
    v_lshl_add_u32 v2, v12, 4, v13
    v_xor_b32 v3, 0x2040, v2
    v_and_b32 v11, 1, v11
    v_lshlrev_b32 v11, 6, v11
    v_lshlrev_b32 v12, 4, v10
    v_xor_b32 v12, v12, v11
    v_mul_u32_u24 v13, 3072, v9
    v_add_u32 v4, v13, v12
    v_mul_u32_u24 v13, 3584, v9
    v_add_u32 v6, v13, v12
    v_xor_b32 v14, 32, v4
    s_and_b32 s9, s2, 3
    s_mul_i32 s9, s9, 5
    s_add_u32 s9, s9, 8
    s_mul_i32 s11, s10, 3
    s_add_u32 s66, s9, s11
    s_add_u32 s67, s66, 1
    s_add_u32 s68, s9, 2
    s_lshl_b32 s61, s6, 7
    s_add_u32 s62, s61, 2048
    s_lshl_b32 s77, s66, 7
    s_add_u32 s78, s61, 1024
    s_movk_i32 s63, 3584
    s_cmp_eq_u32 s5, 0
    s_cselect_b64 vcc, -1, 0
    s_cselect_b32 s61, s78, s61
    s_cselect_b32 s62, s62, s77
    s_cselect_b32 s63, 3072, s63
    s_cselect_b32 s67, s6, s67
    v_cndmask_b32 v5, v6, v14, vcc
    s_lshl_b32 s64, s67, 7
    s_lshl_b32 s65, s68, 7
    s_lshl_b32 s60, s4, 17
    s_lshl_b32 s69, s3, 11
    s_lshl_b32 s70, s3, 10
    s_lshl_b32 s11, s3, 14
    s_add_u32 s76, s60, s11
    s_mul_i32 s11, s3, 24576
    s_add_u32 s11, s61, s11
    v_add_u32 v4, s11, v4
    s_lshl_b32 s11, s3, 3
    s_mul_i32 s11, s11, s63
    s_add_u32 s11, s62, s11
    v_add_u32 v5, s11, v5
    s_lshl_b32 s75, s63, 6
    s_mul_i32 s11, s3, 28672
    s_add_u32 s73, s64, s11
    s_add_u32 s74, s65, s11
    v_add_u32 v7, s74, v6
    v_add_u32 v6, s73, v6
    s_mov_b32 s82, 0
    s_mov_b32 s83, 0
    s_mov_b32 s73, 0
    s_lshl_b32 s79, s5, 3
    s_add_u32 s79, s79, s6
    s_and_b32 s78, s3, 1
    s_lshr_b32 s77, s3, 1
    v_lshlrev_b32 v26, 4, v1
    s_waitcnt lgkmcnt(0)
    s_mov_b32 s14, 2097152
    s_mov_b32 s15, 0x20000
    s_mov_b32 s18, 1572864
    s_mov_b32 s19, 0x20000
    s_mov_b32 s22, 1835008
    s_mov_b32 s23, 0x20000
    s_cmp_eq_u32 s5, 0
    s_cselect_b32 s40, s16, s20
    s_cselect_b32 s41, s17, s21
    s_cselect_b32 s42, s18, s22
    s_mov_b32 s43, 0x20000
    s_lshl_b32 s9, s79, 13
    s_add_u32 s9, s9, s70
    s_add_u32 s9, s9, s60
    buffer_load_dwordx4 v[112:115], v26, s[12:15], s9 offen
    v_lshrrev_b32 v9, 2, v1
    v_and_b32 v10, 3, v1
    v_lshlrev_b32 v10, 4, v10
    s_cmp_eq_u32 s77, 0
    s_cselect_b32 s9, s61, s62
    s_cselect_b32 s11, 3072, s63
    s_cmp_eq_u32 s77, 2
    s_cselect_b32 s9, s64, s9
    s_cmp_eq_u32 s77, 3
    s_cselect_b32 s9, s65, s9
    s_cselect_b32 s71, s10, s78
    s_cmp_ge_u32 s77, 2
    s_cselect_b32 s11, 3584, s11
    s_lshl_b32 s71, s71, 6
    s_add_u32 s9, s9, s71
    s_lshl_b32 s71, s4, 5
    s_mul_i32 s71, s71, s11
    s_add_u32 s9, s9, s71
    v_mul_lo_u32 v9, v9, s11
    v_add_u32 v9, v9, v10
    s_lshl_b32 s11, s11, 4
    s_add_u32 s71, s9, s11
    s_mov_b32 m0, s69
    s_cmp_eq_u32 s11, 49152
    s_cbranch_scc1 L_e1
    buffer_load_dwordx4 v9, s[20:23], s9 offen lds
    s_add_u32 m0, s69, 1024
    s_nop 0
    buffer_load_dwordx4 v9, s[20:23], s71 offen lds
    s_branch L_e2
L_e1:
    s_nop 0
    buffer_load_dwordx4 v9, s[16:19], s9 offen lds
    s_add_u32 m0, s69, 1024
    s_nop 0
    buffer_load_dwordx4 v9, s[16:19], s71 offen lds
L_e2:
    s_add_u32 m0, s69, 16384
    s_nop 0
    buffer_load_dwordx4 v2, s[12:15], s76 offen offset:0 lds
    s_cmp_eq_u32 s5, 0
    s_cbranch_scc1 L_c0b
    s_add_u32 m0, s70, 49152
    s_nop 0
    buffer_load_dwordx4 v6, s[20:23], s73 offen lds
    s_add_u32 m0, s70, 57344
    s_nop 0
    buffer_load_dwordx4 v7, s[20:23], s73 offen lds
    s_add_u32 s73, s73, 229376
L_c0b:
    s_add_u32 m0, s69, 17408
    s_nop 0
    buffer_load_dwordx4 v3, s[12:15], s76 offen offset:0 lds
    s_add_u32 m0, s70, 32768
    s_nop 0
    buffer_load_dwordx4 v4, s[16:19], s82 offen lds
    s_add_u32 s82, s82, 196608
    s_add_u32 m0, s70, 40960
    s_nop 0
    buffer_load_dwordx4 v5, s[40:43], s83 offen lds
    s_add_u32 s83, s83, s75
    s_cmp_eq_u32 s3, 5
    s_cbranch_scc0 L_xt
    v_lshlrev_b32 v255, 10, v1
    s_lshr_b32 s9, s2, 6
    s_lshl_b32 s9, s9, 15
    s_add_u32 s9, s9, s60
    s_lshr_b32 s11, s12, 7
    s_sub_u32 s11, 3, s11
    s_and_b32 s11, s11, 7
    s_lshl_b32 s11, s11, 7
    s_add_u32 s9, s9, s11
    s_mov_b64 exec, 0xffffffff
    buffer_load_dword v255, v255, s[12:15], s9 offen
    s_mov_b64 exec, -1
L_xt:
    s_mov_b32 s26, 9928704
    s_mov_b32 s27, 0x20000
    s_mov_b32 s30, 256
    s_mov_b32 s31, 0x20000
    v_mov_b32 v19, 0
    s_or_b32 s9, s2, s3
    s_cmp_eq_u32 s9, 0
    s_cbranch_scc0 L_nononce
    s_memrealtime s[80:81]
    s_waitcnt lgkmcnt(0)
    s_or_b32 s80, s80, 1
    v_mov_b32 v10, s80
    s_mov_b64 exec, 1
    buffer_store_dword v10, v19, s[28:31], 0 offen sc1
    s_mov_b64 exec, -1
L_nononce:
    s_bfe_u32 s7, s3, 0x10001
    s_lshr_b32 s8, s3, 2
    s_mul_i32 s72, s6, 9216
    s_add_u32 s72, s72, 9437184
    s_cmp_eq_u32 s5, 1
    s_cselect_b32 s9, s4, 1
    s_cmp_eq_u32 s9, 0
    s_cbranch_scc0 L_nozero
    v_lshlrev_b32 v9, 4, v0
    v_mov_b32 v10, 0
    v_mov_b32 v11, 0
    v_mov_b32 v12, 0
    v_mov_b32 v13, 0
    buffer_store_dwordx4 v[10:13], v9, s[24:27], s72 offen sc1
    s_add_u32 s9, s72, 8192
    s_cmp_eq_u32 s3, 0
    s_cbranch_scc0 L_nozero
    buffer_store_dwordx4 v[10:13], v9, s[24:27], s9 offen sc1
L_nozero:
    s_and_b32 s9, s78, s8
    s_cmp_eq_u32 s5, 0
    s_cselect_b32 s61, s8, s9
    v_and_b32 v29, 31, v1
    v_lshrrev_b32 v30, 5, v1
    v_bfe_u32 v31, v1, 1, 3
    v_xor_b32 v31, v31, v30
    v_lshlrev_b32 v20, 7, v29
    v_lshl_add_u32 v8, v31, 4, v20
    s_lshl_b32 s9, s7, 1
    s_add_u32 s62, s9, s61
    s_lshl_b32 s9, s62, 12
    s_add_u32 s9, s9, 16384
    v_add_u32 v8, s9, v8
    v_xor_b32 v9, 32, v8
    v_xor_b32 v10, 64, v8
    v_xor_b32 v11, 96, v8
    v_xor_b32 v12, 0x1000, v8
    v_xor_b32 v13, 0x1000, v9
    v_xor_b32 v14, 0x1000, v10
    v_xor_b32 v15, 0x1000, v11
    v_bfe_u32 v31, v1, 2, 2
    v_lshl_add_u32 v20, v30, 3, v31
    v_and_b32 v22, 3, v1
    v_lshlrev_b32 v22, 3, v22
    v_lshl_add_u32 v18, v20, 6, v22
    v_lshl_add_u32 v20, v20, 7, v22
    v_lshl_add_u32 v21, v30, 2, v31
    v_lshl_add_u32 v21, v21, 5, v22
    v_bfe_u32 v22, v1, 4, 1
    v_lshl_add_u32 v18, v22, 5, v18
    v_add_u32 v18, s69, v18
    v_and_b32 v31, 2, v31
    v_xor_b32 v31, v31, v22
    v_lshl_add_u32 v20, v31, 5, v20
    s_lshl_b32 s9, s8, 1
    s_add_u32 s63, s9, s78
    s_lshl_b32 s9, s63, 5
    v_xor_b32 v23, s9, v20
    v_lshl_add_u32 v23, v22, 13, v23
    s_lshl_b32 s9, s78, 6
    v_xor_b32 v24, s9, v20
    s_cmp_eq_u32 s8, 0
    s_cselect_b32 s10, 8192, 0
    v_add_u32 v25, s10, v24
    v_cndmask_b32 v16, v25, v23, vcc
    v_add_u32 v16, 32768, v16
    s_and_b32 s9, s6, 1
    s_lshl_b32 s9, s9, 6
    v_xor_b32 v25, s9, v20
    v_add_u32 v25, 8192, v25
    s_and_b32 s9, s5, s8
    s_cmp_eq_u32 s9, 1
    s_cselect_b64 s[80:81], -1, 0
    v_cndmask_b32 v17, v24, v25, s[80:81]
    v_add_u32 v17, 49152, v17
    v_mov_b32 v20, v24
    v_mul_u32_u24 v23, 192, v22
    v_lshlrev_b32 v24, 2, v29
    s_lshl_b32 s9, s63, 6
    v_add3_u32 v23, v23, v24, s9
    s_lshl_b32 s9, s78, 7
    s_cmp_eq_u32 s8, 0
    s_cselect_b32 s10, 256, 0
    s_add_u32 s10, s10, s9
    v_add_u32 v25, s10, v24
    v_cndmask_b32 v23, v25, v23, vcc
    s_add_u32 s9, s9, 512
    s_and_b32 s10, s5, s8
    s_cmp_eq_u32 s10, 1
    s_cselect_b32 s9, 768, s9
    v_add_u32 v24, s9, v24
    s_lshl_b32 s66, s66, 1
    s_add_u32 s66, s66, s78
    s_lshl_b32 s67, s67, 1
    s_add_u32 s67, s67, s78
    s_lshl_b32 s68, s68, 1
    s_and_b32 s9, s6, 1
    s_add_u32 s68, s68, s9
    s_cmp_eq_u32 s10, 1
    s_cselect_b32 s67, s68, s67
    s_lshl_b32 s9, s78, 1
    s_cmp_eq_u32 s5, 0
    s_cselect_b32 s9, s63, s9
    s_lshl_b32 s10, s6, 2
    s_add_u32 s65, s10, s9
    s_lshl_b32 s9, s9, 9
    s_add_u32 s9, s9, 14336
    v_add_u32 v21, s9, v21
    v_mov_b32 v22, 0x3f803f80
    v_and_b32 v27, 15, v1
    v_lshlrev_b32 v27, 2, v27
    s_lshl_b32 s9, s4, 7
    s_add_u32 s9, s9, 9531392
    s_lshl_b32 s10, s79, 7
    s_add_u32 s10, s10, 9533440
    v_add_u32 v25, s9, v27
    v_add_u32 v28, s10, v27
    v_lshrrev_b32 v27, 4, v1
    v_cmp_eq_u32 vcc, 1, v27
    s_nop 1
    v_cndmask_b32 v25, v25, v28, vcc
    s_lshl_b32 s9, s6, 2
    s_add_u32 s9, s9, 9531424
    v_writelane_b32 v25, s9, 32
    s_mov_b32 s38, 3584
    s_mov_b32 s39, 0x20000
    s_mov_b32 s34, 16384
    s_mov_b32 s35, 0x20000
    s_mov_b32 s46, 1835008
    s_mov_b32 s47, 0x20000
    s_mov_b32 s50, 524288
    s_mov_b32 s51, 0x20000
    s_mov_b32 s54, 1024
    s_mov_b32 s55, 0x20000
    s_mov_b32 s58, 2097152
    s_mov_b32 s59, 0x20000
    s_waitcnt vmcnt(3)
    ds_read_b64_tr_b16 v[120:121], v18 offset:0
    ds_read_b64_tr_b16 v[122:123], v18 offset:256
    ds_read_b64_tr_b16 v[124:125], v18 offset:1024
    ds_read_b64_tr_b16 v[126:127], v18 offset:1280
    v_mov_b32 v116, 0
    v_mov_b32 v117, 0
    v_mov_b32 v118, 0
    v_dot2_f32_bf16 v116, v112, v22, v116
    v_dot2_f32_bf16 v117, v112, v112, v117
    v_dot2_f32_bf16 v116, v113, v22, v116
    v_dot2_f32_bf16 v117, v113, v113, v117
    v_dot2_f32_bf16 v116, v114, v22, v116
    v_dot2_f32_bf16 v117, v114, v114, v117
    v_dot2_f32_bf16 v116, v115, v22, v116
    v_dot2_f32_bf16 v117, v115, v115, v117
    s_waitcnt lgkmcnt(0)
    v_dot2_f32_bf16 v118, v120, v22, v118
    v_dot2_f32_bf16 v118, v121, v22, v118
    v_dot2_f32_bf16 v118, v122, v22, v118
    v_dot2_f32_bf16 v118, v123, v22, v118
    v_dot2_f32_bf16 v118, v124, v22, v118
    v_dot2_f32_bf16 v118, v125, v22, v118
    v_dot2_f32_bf16 v118, v126, v22, v118
    v_dot2_f32_bf16 v118, v127, v22, v118
    v_add_f32_dpp v116, v116, v116 quad_perm:[1,0,3,2] row_mask:0xf bank_mask:0xf
    v_add_f32_dpp v117, v117, v117 quad_perm:[1,0,3,2] row_mask:0xf bank_mask:0xf
    s_nop 0
    v_add_f32_dpp v116, v116, v116 quad_perm:[2,3,0,1] row_mask:0xf bank_mask:0xf
    v_add_f32_dpp v117, v117, v117 quad_perm:[2,3,0,1] row_mask:0xf bank_mask:0xf
    s_nop 0
    v_add_f32_dpp v116, v116, v116 row_half_mirror row_mask:0xf bank_mask:0xf
    v_add_f32_dpp v117, v117, v117 row_half_mirror row_mask:0xf bank_mask:0xf
    s_nop 0
    v_add_f32_dpp v116, v116, v116 row_mirror row_mask:0xf bank_mask:0xf
    v_add_f32_dpp v117, v117, v117 row_mirror row_mask:0xf bank_mask:0xf
    s_nop 1
    v_permlane16_swap_b32 v116, v117
    v_add_f32 v116, v116, v117
    v_mov_b32 v119, v118
    v_mov_b32 v117, v116
    s_nop 0
    v_permlane32_swap_b32 v118, v119
    v_permlane32_swap_b32 v116, v117
    v_add_f32 v118, v118, v119
    v_add_f32 v116, v116, v117
    v_mov_b32 v117, v116
    s_nop 1
    v_permlane16_swap_b32 v116, v117
    v_mul_f32 v116, 0x3b000000, v116
    v_mul_f32 v117, 0x3b000000, v117
    v_fma_f32 v117, -v116, v116, v117
    v_max_f32 v117, 0, v117
    v_add_f32 v117, 0x3727c5ac, v117
    v_rsq_f32 v114, v117
    v_sub_f32 v116, 0, v116
    v_mul_f32 v117, v117, v114
    v_cvt_pk_bf16_f32 v120, v116, v117
    v_and_b32 v121, 0xffff0000, v120
    v_lshlrev_b32 v122, 16, v120
    v_sub_f32 v123, v116, v122
    v_sub_f32 v124, v117, v121
    v_cvt_pk_bf16_f32 v112, v122, v123
    v_cvt_pk_bf16_f32 v113, v121, v124
    s_lshl_b32 s10, s4, 7
    s_lshl_b32 s11, s79, 3
    s_add_u32 s10, s10, s11
    s_add_u32 s10, s10, s3
    s_lshl_b32 s10, s10, 4
    s_add_u32 s10, s10, 9764864
    s_mul_i32 s11, s79, 14336
    s_mul_i32 s71, s4, 896
    s_add_u32 s11, s11, s71
    s_lshl_b32 s71, s3, 7
    s_add_u32 s11, s11, s71
    s_add_u32 s11, s11, 9535488
    v_lshlrev_b32 v120, 2, v1
    s_mov_b64 exec, 1
    buffer_store_dwordx4 v[112:115], v19, s[24:27], s10 offen sc1
    s_cmp_lt_u32 s3, 7
    s_cselect_b32 exec_lo, -1, 0
    s_cbranch_scc0 L_nocs
    buffer_store_dword v118, v120, s[24:27], s11 offen sc1
L_nocs:
    s_mov_b64 exec, -1
    buffer_load_dword v31, v19, s[28:31], 0 offen sc1
    v_lshlrev_b32 v120, 1, v29
    s_lshl_b32 s9, s66, 6
    s_lshl_b32 s10, s67, 6
    buffer_load_ushort v27, v120, s[36:39], s9 offen
    buffer_load_ushort v28, v120, s[36:39], s10 offen
    s_cmp_eq_u32 s5, 0
    s_cbranch_scc0 L_typeB
    s_add_u32 m0, s69, 65408
    s_nop 0
    buffer_load_dwordx4 v2, s[12:15], s76 offen offset:128 lds
    s_add_u32 m0, s69, 66432
    s_nop 0
    buffer_load_dwordx4 v3, s[12:15], s76 offen offset:128 lds
    s_add_u32 m0, s70, 81920
    s_nop 0
    buffer_load_dwordx4 v4, s[16:19], s82 offen lds
    s_add_u32 s82, s82, 196608
    s_add_u32 m0, s70, 90112
    s_nop 0
    buffer_load_dwordx4 v5, s[40:43], s83 offen lds
    s_add_u32 s83, s83, s75
    v_add_u32 v112, 98304, v8
    v_add_u32 v113, 98304, v9
    v_add_u32 v114, 98304, v10
    v_add_u32 v115, 98304, v11
    v_add_u32 v116, 98304, v12
    v_add_u32 v117, 98304, v13
    v_add_u32 v118, 98304, v14
    v_add_u32 v119, 98304, v15
    v_add_u32 v17, 98304, v16
    v_lshlrev_b32 v121, 2, v30
    v_sub_u32 v121, v29, v121
    v_mov_b32 v122, 0x3f80
    v_mov_b32 v123, 0x3f800000
    v_cmp_eq_u32 vcc, 0, v121
    s_nop 1
    v_cndmask_b32 v64, 0, v122, vcc
    v_cmp_eq_u32 vcc, 1, v121
    s_nop 1
    v_cndmask_b32 v64, v64, v123, vcc
    v_cmp_eq_u32 vcc, 2, v121
    s_nop 1
    v_cndmask_b32 v65, 0, v122, vcc
    v_cmp_eq_u32 vcc, 3, v121
    s_nop 1
    v_cndmask_b32 v65, v65, v123, vcc
    v_cmp_eq_u32 vcc, 8, v121
    s_nop 1
    v_cndmask_b32 v66, 0, v122, vcc
    v_cmp_eq_u32 vcc, 9, v121
    s_nop 1
    v_cndmask_b32 v66, v66, v123, vcc
    v_cmp_eq_u32 vcc, 10, v121
    s_nop 1
    v_cndmask_b32 v67, 0, v122, vcc
    v_cmp_eq_u32 vcc, 11, v121
    s_nop 1
    v_cndmask_b32 v67, v67, v123, vcc
    v_cmp_eq_u32 vcc, 16, v121
    s_nop 1
    v_cndmask_b32 v68, 0, v122, vcc
    v_cmp_eq_u32 vcc, 17, v121
    s_nop 1
    v_cndmask_b32 v68, v68, v123, vcc
    v_cmp_eq_u32 vcc, 18, v121
    s_nop 1
    v_cndmask_b32 v69, 0, v122, vcc
    v_cmp_eq_u32 vcc, 19, v121
    s_nop 1
    v_cndmask_b32 v69, v69, v123, vcc
    v_cmp_eq_u32 vcc, 24, v121
    s_nop 1
    v_cndmask_b32 v70, 0, v122, vcc
    v_cmp_eq_u32 vcc, 25, v121
    s_nop 1
    v_cndmask_b32 v70, v70, v123, vcc
    v_cmp_eq_u32 vcc, 26, v121
    s_nop 1
    v_cndmask_b32 v71, 0, v122, vcc
    v_cmp_eq_u32 vcc, 27, v121
    s_nop 1
    v_cndmask_b32 v71, v71, v123, vcc
    s_waitcnt vmcnt(8)
    s_barrier
    ds_read_b128 v[128:131], v8 offset:0
    ds_read_b64_tr_b16 v[100:101], v16 offset:0
    ds_read_b64_tr_b16 v[102:103], v16 offset:512
    ds_read_b128 v[96:99], v12 offset:0
    s_waitcnt lgkmcnt(0)
    ds_read_b128 v[132:135], v9 offset:0
    ds_read_b64_tr_b16 v[108:109], v16 offset:2048
    ds_read_b64_tr_b16 v[110:111], v16 offset:2560
    ds_read_b128 v[104:107], v13 offset:0
    v_mfma_f32_32x32x16_bf16 v[32:47], v[100:103], v[128:131], 0
    s_add_u32 m0, s69, 114432
    s_nop 0
    buffer_load_dwordx4 v2, s[12:15], s76 offen offset:256 lds
    s_add_u32 m0, s69, 115456
    s_nop 0
    buffer_load_dwordx4 v3, s[12:15], s76 offen offset:256 lds
    v_mfma_f32_32x32x16_bf16 v[48:63], v[100:103], v[96:99], 0
    s_cmp_lt_u32 s3, 2
    s_cbranch_scc0 L_nowpA
    s_add_u32 m0, s70, 14336
    s_lshl_b32 s9, s6, 11
    s_add_u32 s9, s9, s70
    buffer_load_dwordx4 v26, s[32:35], s9 offen lds
L_nowpA:
    s_waitcnt lgkmcnt(0)
    ds_read_b128 v[136:139], v10 offset:0
    ds_read_b64_tr_b16 v[100:101], v16 offset:4096
    ds_read_b64_tr_b16 v[102:103], v16 offset:4608
    ds_read_b128 v[96:99], v14 offset:0
    v_mfma_f32_32x32x16_bf16 v[32:47], v[108:111], v[132:135], v[32:47]
    s_add_u32 m0, s70, 131072
    s_nop 0
    buffer_load_dwordx4 v4, s[16:19], s82 offen lds
    s_add_u32 s82, s82, 196608
    s_add_u32 m0, s70, 139264
    s_nop 0
    buffer_load_dwordx4 v5, s[40:43], s83 offen lds
    s_add_u32 s83, s83, s75
    v_mfma_f32_32x32x16_bf16 v[48:63], v[108:111], v[104:107], v[48:63]
    s_waitcnt lgkmcnt(0)
    ds_read_b128 v[140:143], v11 offset:0
    ds_read_b64_tr_b16 v[108:109], v16 offset:6144
    ds_read_b64_tr_b16 v[110:111], v16 offset:6656
    ds_read_b128 v[104:107], v15 offset:0
    v_mfma_f32_32x32x16_bf16 v[32:47], v[100:103], v[136:139], v[32:47]
    v_mfma_f32_32x32x16_bf16 v[48:63], v[100:103], v[96:99], v[48:63]
    s_waitcnt lgkmcnt(0)
    s_waitcnt vmcnt(4)
    s_barrier
    ds_read_b128 v[144:147], v8 offset:49152
    ds_read_b64_tr_b16 v[100:101], v16 offset:49152
    ds_read_b64_tr_b16 v[102:103], v16 offset:49664
    ds_read_b128 v[96:99], v12 offset:49152
    v_mfma_f32_32x32x16_bf16 v[32:47], v[108:111], v[140:143], v[32:47]
    s_add_u32 m0, s69, 16000
    s_nop 0
    buffer_load_dwordx4 v2, s[12:15], s76 offen offset:384 lds
    v_mfma_f32_32x32x16_bf16 v[48:63], v[108:111], v[104:107], v[48:63]
    s_cmp_eq_u32 s3, 0
    s_cbranch_scc0 L_noflA
    s_mov_b32 s71, 0
L_nspinA:
    v_readfirstlane_b32 s9, v31
    s_add_u32 s71, s71, 1
    s_cmp_gt_u32 s71, 60000
    s_cbranch_scc1 L_nokA
    s_cmp_lg_u32 s9, 0
    s_cbranch_scc1 L_nokA
    buffer_load_dword v31, v19, s[28:31], 0 offen sc1
    s_waitcnt vmcnt(0)
    s_branch L_nspinA
L_nokA:
    s_lshl_b32 s10, s4, 7
    s_lshl_b32 s11, s79, 2
    s_add_u32 s10, s10, s11
    s_lshl_b32 s11, s79, 7
    s_lshl_b32 s71, s4, 2
    s_add_u32 s11, s11, s71
    s_add_u32 s11, s11, 2048
    v_mov_b32 v90, s10
    v_writelane_b32 v90, s11, 1
    s_mov_b32 s10, 9531392
    s_mov_b64 exec, 3
    buffer_store_dword v31, v90, s[24:27], s10 offen sc1
    s_mov_b64 exec, -1
L_noflA:
    s_waitcnt lgkmcnt(0)
    ds_read_b128 v[148:151], v9 offset:49152
    ds_read_b64_tr_b16 v[108:109], v16 offset:51200
    ds_read_b64_tr_b16 v[110:111], v16 offset:51712
    ds_read_b128 v[104:107], v13 offset:49152
    v_mfma_f32_32x32x16_bf16 v[32:47], v[100:103], v[144:147], v[32:47]
    s_add_u32 m0, s69, 17024
    s_nop 0
    buffer_load_dwordx4 v3, s[12:15], s76 offen offset:384 lds
    v_mfma_f32_32x32x16_bf16 v[48:63], v[100:103], v[96:99], v[48:63]
    s_waitcnt lgkmcnt(0)
    ds_read_b128 v[152:155], v10 offset:49152
    ds_read_b64_tr_b16 v[100:101], v16 offset:53248
    ds_read_b64_tr_b16 v[102:103], v16 offset:53760
    ds_read_b128 v[96:99], v14 offset:49152
    v_mfma_f32_32x32x16_bf16 v[32:47], v[108:111], v[148:151], v[32:47]
    s_add_u32 m0, s70, 32768
    s_nop 0
    buffer_load_dwordx4 v4, s[16:19], s82 offen lds
    s_add_u32 s82, s82, 196608
    v_mfma_f32_32x32x16_bf16 v[48:63], v[108:111], v[104:107], v[48:63]
    s_waitcnt lgkmcnt(0)
    ds_read_b128 v[156:159], v11 offset:49152
    ds_read_b64_tr_b16 v[108:109], v16 offset:55296
    ds_read_b64_tr_b16 v[110:111], v16 offset:55808
    ds_read_b128 v[104:107], v15 offset:49152
    v_mfma_f32_32x32x16_bf16 v[32:47], v[100:103], v[152:155], v[32:47]
    s_add_u32 m0, s70, 40960
    s_nop 0
    buffer_load_dwordx4 v5, s[40:43], s83 offen lds
    s_add_u32 s83, s83, s75
    v_mfma_f32_32x32x16_bf16 v[48:63], v[100:103], v[96:99], v[48:63]
    s_waitcnt lgkmcnt(0)
    s_waitcnt vmcnt(4)
    s_barrier
    ds_read_b128 v[160:163], v112 offset:0
    ds_read_b64_tr_b16 v[100:101], v17 offset:0
    ds_read_b64_tr_b16 v[102:103], v17 offset:512
    ds_read_b128 v[96:99], v116 offset:0
    v_mfma_f32_32x32x16_bf16 v[32:47], v[108:111], v[156:159], v[32:47]
    s_add_u32 m0, s69, 65024
    s_nop 0
    buffer_load_dwordx4 v2, s[12:15], s76 offen offset:512 lds
    v_mfma_f32_32x32x16_bf16 v[48:63], v[108:111], v[104:107], v[48:63]
    s_waitcnt lgkmcnt(0)
    ds_read_b128 v[164:167], v113 offset:0
    ds_read_b64_tr_b16 v[108:109], v17 offset:2048
    ds_read_b64_tr_b16 v[110:111], v17 offset:2560
    ds_read_b128 v[104:107], v117 offset:0
    v_mfma_f32_32x32x16_bf16 v[32:47], v[100:103], v[160:163], v[32:47]
    s_add_u32 m0, s69, 66048
    s_nop 0
    buffer_load_dwordx4 v3, s[12:15], s76 offen offset:512 lds
    v_mfma_f32_32x32x16_bf16 v[48:63], v[100:103], v[96:99], v[48:63]
    s_cmp_lt_u32 s3, 6
    s_cbranch_scc1 L_sl3A
    s_lshr_b32 s9, s2, 3
    v_lshlrev_b32 v94, 10, v1
    s_cmp_eq_u32 s3, 6
    s_cbranch_scc1 L_sl1A
    s_lshr_b32 s10, s44, 7
    s_sub_u32 s10, 3, s10
    s_and_b32 s10, s10, 7
    s_lshl_b32 s10, s10, 7
    s_mul_i32 s9, s9, 57344
    s_add_u32 s9, s9, s10
    s_mov_b32 exec_hi, 0xffffff
    buffer_load_dword v94, v94, s[44:47], s9 offen
    s_branch L_sl2A
L_sl1A:
    s_lshr_b32 s10, s48, 7
    s_sub_u32 s10, 3, s10
    s_and_b32 s10, s10, 7
    s_lshl_b32 s10, s10, 7
    s_lshl_b32 s9, s9, 14
    s_add_u32 s9, s9, s10
    s_mov_b64 exec, 0xffff
    buffer_load_dword v94, v94, s[48:51], s9 offen
L_sl2A:
    s_mov_b64 exec, -1
L_sl3A:
    ds_read_b64_tr_b16 v[72:73], v21 offset:0
    ds_read_b64_tr_b16 v[74:75], v21 offset:256
    s_waitcnt lgkmcnt(0)
    ds_read_b128 v[168:171], v114 offset:0
    ds_read_b64_tr_b16 v[100:101], v17 offset:4096
    ds_read_b64_tr_b16 v[102:103], v17 offset:4608
    ds_read_b128 v[96:99], v118 offset:0
    v_mfma_f32_32x32x16_bf16 v[32:47], v[108:111], v[164:167], v[32:47]
    s_add_u32 m0, s70, 81920
    s_nop 0
    buffer_load_dwordx4 v4, s[16:19], s82 offen lds
    s_add_u32 s82, s82, 196608
    v_mfma_f32_32x32x16_bf16 v[48:63], v[108:111], v[104:107], v[48:63]
    s_waitcnt lgkmcnt(0)
    ds_read_b128 v[172:175], v115 offset:0
    ds_read_b64_tr_b16 v[108:109], v17 offset:6144
    ds_read_b64_tr_b16 v[110:111], v17 offset:6656
    ds_read_b128 v[104:107], v119 offset:0
    v_mfma_f32_32x32x16_bf16 v[32:47], v[100:103], v[168:171], v[32:47]
    s_add_u32 m0, s70, 90112
    s_nop 0
    buffer_load_dwordx4 v5, s[40:43], s83 offen lds
    s_add_u32 s83, s83, s75
    v_mfma_f32_32x32x16_bf16 v[48:63], v[100:103], v[96:99], v[48:63]
    s_waitcnt lgkmcnt(0)
    s_waitcnt vmcnt(4)
    s_barrier
    ds_read_b128 v[176:179], v8 offset:0
    ds_read_b64_tr_b16 v[100:101], v16 offset:0
    ds_read_b64_tr_b16 v[102:103], v16 offset:512
    ds_read_b128 v[96:99], v12 offset:0
    v_mfma_f32_32x32x16_bf16 v[32:47], v[108:111], v[172:175], v[32:47]
    s_add_u32 m0, s69, 114048
    s_nop 0
    buffer_load_dwordx4 v2, s[12:15], s76 offen offset:640 lds
    v_mfma_f32_32x32x16_bf16 v[48:63], v[108:111], v[104:107], v[48:63]
    s_waitcnt lgkmcnt(0)
    ds_read_b128 v[180:183], v9 offset:0
    ds_read_b64_tr_b16 v[108:109], v16 offset:2048
    ds_read_b64_tr_b16 v[110:111], v16 offset:2560
    ds_read_b128 v[104:107], v13 offset:0
    v_mfma_f32_32x32x16_bf16 v[32:47], v[100:103], v[176:179], v[32:47]
    s_add_u32 m0, s69, 115072
    s_nop 0
    buffer_load_dwordx4 v3, s[12:15], s76 offen offset:640 lds
    v_mfma_f32_32x32x16_bf16 v[48:63], v[100:103], v[96:99], v[48:63]
    s_waitcnt lgkmcnt(0)
    ds_read_b128 v[184:187], v10 offset:0
    ds_read_b64_tr_b16 v[100:101], v16 offset:4096
    ds_read_b64_tr_b16 v[102:103], v16 offset:4608
    ds_read_b128 v[96:99], v14 offset:0
    v_mfma_f32_32x32x16_bf16 v[32:47], v[108:111], v[180:183], v[32:47]
    s_add_u32 m0, s70, 131072
    s_nop 0
    buffer_load_dwordx4 v4, s[16:19], s82 offen lds
    s_add_u32 s82, s82, 196608
    v_mfma_f32_32x32x16_bf16 v[48:63], v[108:111], v[104:107], v[48:63]
    s_waitcnt lgkmcnt(0)
    ds_read_b128 v[188:191], v11 offset:0
    ds_read_b64_tr_b16 v[108:109], v16 offset:6144
    ds_read_b64_tr_b16 v[110:111], v16 offset:6656
    ds_read_b128 v[104:107], v15 offset:0
    v_mfma_f32_32x32x16_bf16 v[32:47], v[100:103], v[184:187], v[32:47]
    s_add_u32 m0, s70, 139264
    s_nop 0
    buffer_load_dwordx4 v5, s[40:43], s83 offen lds
    s_add_u32 s83, s83, s75
    v_mfma_f32_32x32x16_bf16 v[48:63], v[100:103], v[96:99], v[48:63]
    s_waitcnt lgkmcnt(0)
    s_waitcnt vmcnt(4)
    s_barrier
    ds_read_b128 v[192:195], v8 offset:49152
    ds_read_b64_tr_b16 v[100:101], v16 offset:49152
    ds_read_b64_tr_b16 v[102:103], v16 offset:49664
    ds_read_b128 v[96:99], v12 offset:49152
    v_mfma_f32_32x32x16_bf16 v[32:47], v[108:111], v[188:191], v[32:47]
    s_add_u32 m0, s69, 15616
    s_nop 0
    buffer_load_dwordx4 v2, s[12:15], s76 offen offset:768 lds
    v_mfma_f32_32x32x16_bf16 v[48:63], v[108:111], v[104:107], v[48:63]
    s_waitcnt lgkmcnt(0)
    ds_read_b128 v[196:199], v9 offset:49152
    ds_read_b64_tr_b16 v[108:109], v16 offset:51200
    ds_read_b64_tr_b16 v[110:111], v16 offset:51712
    ds_read_b128 v[104:107], v13 offset:49152
    v_mfma_f32_32x32x16_bf16 v[32:47], v[100:103], v[192:195], v[32:47]
    s_add_u32 m0, s69, 16640
    s_nop 0
    buffer_load_dwordx4 v3, s[12:15], s76 offen offset:768 lds
    v_mfma_f32_32x32x16_bf16 v[48:63], v[100:103], v[96:99], v[48:63]
    s_waitcnt lgkmcnt(0)
    ds_read_b128 v[200:203], v10 offset:49152
    ds_read_b64_tr_b16 v[100:101], v16 offset:53248
    ds_read_b64_tr_b16 v[102:103], v16 offset:53760
    ds_read_b128 v[96:99], v14 offset:49152
    v_mfma_f32_32x32x16_bf16 v[32:47], v[108:111], v[196:199], v[32:47]
    s_add_u32 m0, s70, 32768
    s_nop 0
    buffer_load_dwordx4 v4, s[16:19], s82 offen lds
    s_add_u32 s82, s82, 196608
    v_mfma_f32_32x32x16_bf16 v[48:63], v[108:111], v[104:107], v[48:63]
    s_cmp_eq_u32 s3, 0
    s_cbranch_scc0 L_npiA
    buffer_load_dword v18, v25, s[24:27], 0 offen sc1
L_npiA:
    s_waitcnt lgkmcnt(0)
    ds_read_b128 v[204:207], v11 offset:49152
    ds_read_b64_tr_b16 v[108:109], v16 offset:55296
    ds_read_b64_tr_b16 v[110:111], v16 offset:55808
    ds_read_b128 v[104:107], v15 offset:49152
    v_mfma_f32_32x32x16_bf16 v[32:47], v[100:103], v[200:203], v[32:47]
    s_add_u32 m0, s70, 40960
    s_nop 0
    buffer_load_dwordx4 v5, s[40:43], s83 offen lds
    s_add_u32 s83, s83, s75
    v_mfma_f32_32x32x16_bf16 v[48:63], v[100:103], v[96:99], v[48:63]
    s_waitcnt lgkmcnt(0)
    s_waitcnt vmcnt(4)
    s_barrier
    ds_read_b128 v[208:211], v112 offset:0
    ds_read_b64_tr_b16 v[100:101], v17 offset:0
    ds_read_b64_tr_b16 v[102:103], v17 offset:512
    ds_read_b128 v[96:99], v116 offset:0
    v_mfma_f32_32x32x16_bf16 v[32:47], v[108:111], v[204:207], v[32:47]
    s_add_u32 m0, s69, 64640
    s_nop 0
    buffer_load_dwordx4 v2, s[12:15], s76 offen offset:896 lds
    v_mfma_f32_32x32x16_bf16 v[48:63], v[108:111], v[104:107], v[48:63]
    s_waitcnt lgkmcnt(0)
    ds_read_b128 v[212:215], v113 offset:0
    ds_read_b64_tr_b16 v[108:109], v17 offset:2048
    ds_read_b64_tr_b16 v[110:111], v17 offset:2560
    ds_read_b128 v[104:107], v117 offset:0
    v_mfma_f32_32x32x16_bf16 v[32:47], v[100:103], v[208:211], v[32:47]
    s_add_u32 m0, s69, 65664
    s_nop 0
    buffer_load_dwordx4 v3, s[12:15], s76 offen offset:896 lds
    v_mfma_f32_32x32x16_bf16 v[48:63], v[100:103], v[96:99], v[48:63]
    s_waitcnt lgkmcnt(0)
    ds_read_b128 v[216:219], v114 offset:0
    ds_read_b64_tr_b16 v[100:101], v17 offset:4096
    ds_read_b64_tr_b16 v[102:103], v17 offset:4608
    ds_read_b128 v[96:99], v118 offset:0
    v_mfma_f32_32x32x16_bf16 v[32:47], v[108:111], v[212:215], v[32:47]
    s_add_u32 m0, s70, 81920
    s_nop 0
    buffer_load_dwordx4 v4, s[16:19], s82 offen lds
    s_add_u32 s82, s82, 196608
    v_mfma_f32_32x32x16_bf16 v[48:63], v[108:111], v[104:107], v[48:63]
    s_waitcnt lgkmcnt(0)
    ds_read_b128 v[220:223], v115 offset:0
    ds_read_b64_tr_b16 v[108:109], v17 offset:6144
    ds_read_b64_tr_b16 v[110:111], v17 offset:6656
    ds_read_b128 v[104:107], v119 offset:0
    v_mfma_f32_32x32x16_bf16 v[32:47], v[100:103], v[216:219], v[32:47]
    s_add_u32 m0, s70, 90112
    s_nop 0
    buffer_load_dwordx4 v5, s[40:43], s83 offen lds
    s_add_u32 s83, s83, s75
    v_mfma_f32_32x32x16_bf16 v[48:63], v[100:103], v[96:99], v[48:63]
    s_waitcnt lgkmcnt(0)
    s_waitcnt vmcnt(4)
    s_cmp_eq_u32 s3, 0
    s_cbranch_scc0 L_fok2A
    s_mov_b32 s71, 0
L_fspinA:
    v_cmp_ne_u32 vcc, v18, v31
    s_cmp_eq_u64 vcc, 0
    s_cbranch_scc1 L_fokA
    s_add_u32 s71, s71, 1
    s_cmp_gt_u32 s71, 60000
    s_cbranch_scc1 L_fokA
    s_sleep 8
    buffer_load_dword v18, v25, s[24:27], 0 offen sc1
    s_waitcnt vmcnt(0)
    s_branch L_fspinA
L_fokA:
    ds_write_b32 v19, v31 offset:16380
    s_waitcnt lgkmcnt(0)
L_fok2A:
    s_barrier
    ds_read_b128 v[224:227], v8 offset:0
    ds_read_b64_tr_b16 v[100:101], v16 offset:0
    ds_read_b64_tr_b16 v[102:103], v16 offset:512
    ds_read_b128 v[96:99], v12 offset:0
    v_mfma_f32_32x32x16_bf16 v[32:47], v[108:111], v[220:223], v[32:47]
    v_mfma_f32_32x32x16_bf16 v[48:63], v[108:111], v[104:107], v[48:63]
    ds_read_b32 v31, v19 offset:16380
    v_lshlrev_b32 v92, 4, v29
    s_lshl_b32 s9, s4, 11
    s_lshl_b32 s10, s62, 9
    s_add_u32 s9, s9, s10
    s_add_u32 s9, s9, 9764864
    s_xor_b32 s10, s9, 512
    s_cmp_lt_u32 s3, 7
    s_cbranch_scc0 L_nocsdA
    s_mul_i32 s11, s79, 14336
    s_add_u32 s11, s11, s69
    s_add_u32 s11, s11, 9535488
    s_mov_b32 m0, s69
    s_nop 0
    buffer_load_dwordx4 v26, s[24:27], s11 offen sc1 lds
    buffer_load_dwordx4 v26, s[24:27], s11 offen offset:1024 sc1 lds
L_nocsdA:
    buffer_load_dwordx4 v[120:123], v92, s[24:27], s9 offen sc1
    buffer_load_dwordx4 v[124:127], v92, s[24:27], s10 offen sc1
    s_waitcnt lgkmcnt(0)
    ds_read_b128 v[228:231], v9 offset:0
    ds_read_b64_tr_b16 v[108:109], v16 offset:2048
    ds_read_b64_tr_b16 v[110:111], v16 offset:2560
    ds_read_b128 v[104:107], v13 offset:0
    v_mfma_f32_32x32x16_bf16 v[32:47], v[100:103], v[224:227], v[32:47]
    v_mfma_f32_32x32x16_bf16 v[48:63], v[100:103], v[96:99], v[48:63]
    v_readfirstlane_b32 s75, v31
    v_lshrrev_b32 v90, 3, v1
    v_and_b32 v91, 7, v1
    v_lshrrev_b32 v92, 2, v1
    v_and_b32 v92, 4, v92
    v_xor_b32 v91, v91, v92
    v_lshlrev_b32 v90, 10, v90
    v_lshl_add_u32 v18, v91, 4, v90
    s_lshl_b32 s74, s4, 2
    s_add_u32 s74, s74, s62
    s_xor_b32 s64, s74, 1
    s_mul_i32 s74, s74, 147456
    s_mul_i32 s64, s64, 147456
    s_and_b32 s82, s2, 7
    s_lshl_b32 s82, s82, 2
    s_bfe_u32 s9, s2, 0x20003
    s_add_u32 s82, s82, s9
    s_lshr_b32 s62, s2, 5
    s_mul_i32 s76, s62, 7
    s_lshr_b32 s76, s76, 2
    s_mul_i32 s9, s9, 3
    s_add_u32 s76, s76, s9
    s_lshl_b32 s62, s62, 7
    s_mul_i32 s60, s3, 229376
    s_add_u32 s60, s60, s62
    s_add_u32 s83, s60, 229376
    s_lshl_b32 s68, s3, 16
    s_add_u32 s68, s68, s62
    s_cmp_ge_u32 s76, 14
    s_cselect_b32 s9, 14, 0
    s_sub_u32 s76, s76, s9
    s_lshl_b32 s61, s76, 14
    s_add_u32 s61, s61, s60
    s_add_u32 m0, s69, 114688
    s_add_u32 s71, s61, 8192
    buffer_load_dwordx4 v18, s[44:47], s61 offen lds
    s_add_u32 m0, s69, 115712
    s_nop 0
    buffer_load_dwordx4 v18, s[44:47], s71 offen lds
    s_add_u32 s61, s61, 16384
    s_cmp_eq_u32 s61, s83
    s_cselect_b32 s61, s60, s61
    s_waitcnt lgkmcnt(0)
    ds_read_b128 v[232:235], v10 offset:0
    ds_read_b64_tr_b16 v[100:101], v16 offset:4096
    ds_read_b64_tr_b16 v[102:103], v16 offset:4608
    ds_read_b128 v[96:99], v14 offset:0
    v_mfma_f32_32x32x16_bf16 v[32:47], v[108:111], v[228:231], v[32:47]
    v_mfma_f32_32x32x16_bf16 v[48:63], v[108:111], v[104:107], v[48:63]
    s_add_u32 m0, s69, 131072
    s_add_u32 s71, s61, 8192
    buffer_load_dwordx4 v18, s[44:47], s61 offen lds
    s_add_u32 m0, s69, 132096
    s_nop 0
    buffer_load_dwordx4 v18, s[44:47], s71 offen lds
    s_add_u32 s61, s61, 16384
    s_cmp_eq_u32 s61, s83
    s_cselect_b32 s61, s60, s61
    s_waitcnt lgkmcnt(0)
    ds_read_b128 v[236:239], v11 offset:0
    ds_read_b64_tr_b16 v[108:109], v16 offset:6144
    ds_read_b64_tr_b16 v[110:111], v16 offset:6656
    ds_read_b128 v[104:107], v15 offset:0
    v_mfma_f32_32x32x16_bf16 v[32:47], v[100:103], v[232:235], v[32:47]
    v_mfma_f32_32x32x16_bf16 v[48:63], v[100:103], v[96:99], v[48:63]
    s_add_u32 m0, s69, 147456
    s_add_u32 s71, s61, 8192
    buffer_load_dwordx4 v18, s[44:47], s61 offen lds
    s_add_u32 m0, s69, 148480
    s_nop 0
    buffer_load_dwordx4 v18, s[44:47], s71 offen lds
    s_add_u32 s61, s61, 16384
    s_cmp_eq_u32 s61, s83
    s_cselect_b32 s61, s60, s61
    s_waitcnt lgkmcnt(0)
    s_waitcnt vmcnt(8)
    s_barrier
    ds_read_b128 v[240:243], v8 offset:49152
    ds_read_b64_tr_b16 v[100:101], v16 offset:49152
    ds_read_b64_tr_b16 v[102:103], v16 offset:49664
    ds_read_b128 v[96:99], v12 offset:49152
    v_mfma_f32_32x32x16_bf16 v[32:47], v[108:111], v[236:239], v[32:47]
    v_mfma_f32_32x32x16_bf16 v[48:63], v[108:111], v[104:107], v[48:63]
    s_waitcnt lgkmcnt(0)
    ds_read_b128 v[244:247], v9 offset:49152
    ds_read_b64_tr_b16 v[108:109], v16 offset:51200
    ds_read_b64_tr_b16 v[110:111], v16 offset:51712
    ds_read_b128 v[104:107], v13 offset:49152
    v_mfma_f32_32x32x16_bf16 v[32:47], v[100:103], v[240:243], v[32:47]
    v_mfma_f32_32x32x16_bf16 v[48:63], v[100:103], v[96:99], v[48:63]
    s_add_u32 m0, s69, 16384
    s_add_u32 s71, s61, 8192
    buffer_load_dwordx4 v18, s[44:47], s61 offen lds
    s_add_u32 m0, s69, 17408
    s_nop 0
    buffer_load_dwordx4 v18, s[44:47], s71 offen lds
    s_add_u32 s61, s61, 16384
    s_cmp_eq_u32 s61, s83
    s_cselect_b32 s61, s60, s61
    s_waitcnt lgkmcnt(0)
    ds_read_b128 v[248:251], v10 offset:49152
    ds_read_b64_tr_b16 v[100:101], v16 offset:53248
    ds_read_b64_tr_b16 v[102:103], v16 offset:53760
    ds_read_b128 v[96:99], v14 offset:49152
    v_mfma_f32_32x32x16_bf16 v[32:47], v[108:111], v[244:247], v[32:47]
    v_mfma_f32_32x32x16_bf16 v[48:63], v[108:111], v[104:107], v[48:63]
    s_waitcnt lgkmcnt(0)
    ds_read_b128 v[252:255], v11 offset:49152
    ds_read_b64_tr_b16 v[108:109], v16 offset:55296
    ds_read_b64_tr_b16 v[110:111], v16 offset:55808
    ds_read_b128 v[104:107], v15 offset:49152
    v_mfma_f32_32x32x16_bf16 v[32:47], v[100:103], v[248:251], v[32:47]
    v_mfma_f32_32x32x16_bf16 v[48:63], v[100:103], v[96:99], v[48:63]
    s_waitcnt lgkmcnt(0)
    v_mfma_f32_32x32x16_bf16 v[32:47], v[108:111], v[252:255], v[32:47]
    v_mfma_f32_32x32x16_bf16 v[48:63], v[108:111], v[104:107], v[48:63]
    s_waitcnt vmcnt(8)
    s_barrier
    s_cmp_lt_u32 s3, 4
    s_cbranch_scc0 L_noredA
    v_min_u32 v92, 223, v0
    v_lshlrev_b32 v92, 2, v92
    ds_read_b32 v96, v92 offset:0
    ds_read_b32 v97, v92 offset:896
    ds_read_b32 v98, v92 offset:1792
    ds_read_b32 v99, v92 offset:2688
    ds_read_b32 v100, v92 offset:3584
    ds_read_b32 v101, v92 offset:4480
    ds_read_b32 v102, v92 offset:5376
    ds_read_b32 v103, v92 offset:6272
    ds_read_b32 v104, v92 offset:7168
    ds_read_b32 v105, v92 offset:8064
    ds_read_b32 v106, v92 offset:8960
    ds_read_b32 v107, v92 offset:9856
    ds_read_b32 v108, v92 offset:10752
    ds_read_b32 v109, v92 offset:11648
    ds_read_b32 v110, v92 offset:12544
    ds_read_b32 v111, v92 offset:13440
    s_waitcnt lgkmcnt(0)
    v_add_f32 v96, v96, v104
    v_add_f32 v97, v97, v105
    v_add_f32 v98, v98, v106
    v_add_f32 v99, v99, v107
    v_add_f32 v100, v100, v108
    v_add_f32 v101, v101, v109
    v_add_f32 v102, v102, v110
    v_add_f32 v103, v103, v111
    v_add_f32 v96, v96, v100
    v_add_f32 v97, v97, v101
    v_add_f32 v98, v98, v102
    v_add_f32 v99, v99, v103
    v_add_f32 v96, v96, v98
    v_add_f32 v97, v97, v99
    v_add_f32 v96, v96, v97
    v_cvt_pk_bf16_f32 v97, v96, v96
    v_and_b32 v97, 0xffff0000, v97
    v_sub_f32 v98, v96, v97
    v_cvt_pk_bf16_f32 v96, v97, v98
    ds_write_b32 v92, v96
L_noredA:
    v_and_b32 v92, 0xffff, v120
    v_lshl_or_b32 v76, v92, 16, v92
    v_lshrrev_b32 v92, 16, v120
    v_lshl_or_b32 v77, v92, 16, v92
    v_mov_b32 v78, v121
    v_mov_b32 v79, 0
    v_mov_b32 v84, v122
    v_mul_f32 v85, 0x3fb8aa3b, v122
    v_mul_f32 v86, 0.5, v122
    v_and_b32 v92, 0xffff, v124
    v_lshl_or_b32 v80, v92, 16, v92
    v_lshrrev_b32 v92, 16, v124
    v_lshl_or_b32 v81, v92, 16, v92
    v_mov_b32 v82, v125
    v_mov_b32 v83, 0
    v_mov_b32 v87, v126
    v_mul_f32 v88, 0x3fb8aa3b, v126
    v_mul_f32 v89, 0.5, v126
    v_mov_b32 v95, v6
    s_waitcnt lgkmcnt(0)
    s_barrier
    ds_read_b32 v120, v23
    ds_read_b32 v4, v24
    v_cmp_gt_u32 vcc, 32, v1
    v_lshl_or_b32 v28, v28, 16, v28
    s_nop 0
    v_cndmask_b32 v6, 0, v28, vcc
    v_cmp_eq_u32 s[80:81], 16, v29
    s_nop 1
    v_cndmask_b32 v27, 0, v22, s[80:81]
    v_mov_b32 v122, 0
    v_mov_b32 v123, 0
    v_mov_b32 v7, 0
    s_waitcnt lgkmcnt(0)
    v_cndmask_b32 v120, 0, v120, vcc
    v_cndmask_b32 v4, 0, v4, vcc
    v_mov_b32 v121, v120
    v_mov_b32 v5, v4
    s_nop 0
    v_mfma_f32_32x32x16_bf16 v[32:47], v[120:123], v[76:79], v[32:47]
    v_mfma_f32_32x32x16_bf16 v[48:63], v[120:123], v[80:83], v[48:63]
    v_mov_b32 v90, v18
    v_mov_b32 v91, v20
    s_nop 8
    v_cvt_pk_bf16_f32 v120, v32, v33
    v_cvt_pk_bf16_f32 v121, v34, v35
    v_cvt_pk_bf16_f32 v122, v36, v37
    s_add_u32 m0, s70, 49152
    v_cvt_pk_bf16_f32 v123, v38, v39
    s_nop 1
    v_mfma_f32_32x32x16_bf16 v[96:111], v[72:75], v[120:123], 0
    v_mul_f32 v40, v40, v84
    v_mul_f32 v41, v41, v84
    v_mul_f32 v42, v42, v84
    v_mul_f32 v43, v43, v84
    v_mul_f32 v44, v44, v84
    buffer_load_dwordx4 v95, s[20:23], s73 offen lds
    v_mul_f32 v45, v45, v84
    v_mul_f32 v46, v46, v84
    v_mul_f32 v47, v47, v84
    v_cvt_pk_bf16_f32 v120, v40, v41
    v_cvt_pk_bf16_f32 v121, v42, v43
    v_cvt_pk_bf16_f32 v122, v44, v45
    v_cvt_pk_bf16_f32 v123, v46, v47
    s_add_u32 s73, s73, 229376
    s_nop 0
    v_mfma_f32_32x32x16_bf16 v[32:47], v[120:123], v[64:67], 0
    v_max3_f32 v2, v96, v97, v98
    v_max3_f32 v3, -v96, -v97, -v98
    v_max3_f32 v2, v2, v99, v100
    v_max3_f32 v3, v3, -v99, -v100
    v_max3_f32 v2, v2, v101, v102
    s_add_u32 m0, s70, 57344
    v_max3_f32 v3, v3, -v101, -v102
    v_max_f32 v2, v2, v103
    v_max_f32_e64 v3, v3, -v103
    s_nop 1
    v_permlane32_swap_b32 v2, v3
    v_max_f32 v2, v2, v3
    v_mul_f32_e64 v2, -v2, v85
    v_mov_b32 v3, v2
    buffer_load_dwordx4 v95, s[20:23], s73 offen lds
    s_nop 0
    v_permlane32_swap_b32 v2, v3
    v_fma_f32 v112, -v96, v85, v3
    v_fma_f32 v96, v96, v85, v2
    v_fma_f32 v113, -v97, v85, v3
    v_fma_f32 v97, v97, v85, v2
    v_fma_f32 v114, -v98, v85, v3
    v_fma_f32 v98, v98, v85, v2
    s_add_u32 s73, s73, 229376
    v_fma_f32 v115, -v99, v85, v3
    v_fma_f32 v99, v99, v85, v2
    v_fma_f32 v116, -v100, v85, v3
    v_fma_f32 v100, v100, v85, v2
    v_fma_f32 v117, -v101, v85, v3
    v_fma_f32 v101, v101, v85, v2
    s_add_u32 m0, s70, 65536
    v_fma_f32 v118, -v102, v85, v3
    v_fma_f32 v102, v102, v85, v2
    v_fma_f32 v119, -v103, v85, v3
    v_fma_f32 v103, v103, v85, v2
    v_exp_f32 v112, v112
    v_exp_f32 v96, v96
    v_exp_f32 v113, v113
    buffer_load_dwordx4 v95, s[20:23], s73 offen lds
    v_exp_f32 v97, v97
    v_exp_f32 v114, v114
    v_exp_f32 v98, v98
    v_exp_f32 v115, v115
    v_exp_f32 v99, v99
    v_exp_f32 v116, v116
    v_exp_f32 v100, v100
    s_add_u32 s73, s73, 229376
    v_exp_f32 v117, v117
    v_exp_f32 v101, v101
    v_exp_f32 v118, v118
    v_exp_f32 v102, v102
    v_exp_f32 v119, v119
    v_exp_f32 v103, v103
    s_add_u32 m0, s70, 73728
    v_add_f32 v2, v96, v97
    v_add_f32 v3, v112, v113
    v_add_f32 v2, v2, v98
    v_add_f32 v3, v3, v114
    v_add_f32 v2, v2, v99
    v_add_f32 v3, v3, v115
    v_add_f32 v2, v2, v100
    buffer_load_dwordx4 v95, s[20:23], s73 offen lds
    v_add_f32 v3, v3, v116
    v_add_f32 v2, v2, v101
    v_add_f32 v3, v3, v117
    v_add_f32 v2, v2, v102
    v_add_f32 v3, v3, v118
    v_add_f32 v2, v2, v103
    v_add_f32 v3, v3, v119
    s_add_u32 s73, s73, 229376
    s_nop 0
    v_permlane32_swap_b32 v2, v3
    v_add_f32 v2, v2, v3
    v_rcp_f32 v2, v2
    s_nop 0
    v_mov_b32 v3, v2
    s_nop 1
    v_permlane32_swap_b32 v2, v3
    v_mul_f32 v96, v96, v2
    s_add_u32 m0, s70, 81920
    v_mul_f32 v112, v112, v3
    v_mul_f32 v97, v97, v2
    v_mul_f32 v113, v113, v3
    v_mul_f32 v98, v98, v2
    v_mul_f32 v114, v114, v3
    v_mul_f32 v99, v99, v2
    v_mul_f32 v115, v115, v3
    buffer_load_dwordx4 v95, s[20:23], s73 offen lds
    v_mul_f32 v100, v100, v2
    v_mul_f32 v116, v116, v3
    v_mul_f32 v101, v101, v2
    v_mul_f32 v117, v117, v3
    v_mul_f32 v102, v102, v2
    v_mul_f32 v118, v118, v3
    v_mul_f32 v103, v103, v2
    s_add_u32 s73, s73, 229376
    v_mul_f32 v119, v119, v3
    v_cvt_pk_bf16_f32 v120, v96, v97
    v_cvt_pk_bf16_f32 v124, v112, v113
    v_cvt_pk_bf16_f32 v121, v98, v99
    v_cvt_pk_bf16_f32 v125, v114, v115
    v_cvt_pk_bf16_f32 v122, v100, v101
    s_add_u32 m0, s70, 90112
    v_cvt_pk_bf16_f32 v126, v116, v117
    v_cvt_pk_bf16_f32 v123, v102, v103
    v_cvt_pk_bf16_f32 v127, v118, v119
    s_nop 0
    v_mfma_f32_32x32x16_bf16 v[96:111], v[120:123], v[64:67], 0
    v_mfma_f32_32x32x16_bf16 v[96:111], v[124:127], v[68:71], v[96:111]
    v_cvt_pk_bf16_f32 v112, v32, v33
    v_or_b32 v112, v112, v27
    buffer_load_dwordx4 v95, s[20:23], s73 offen lds
    v_cvt_pk_bf16_f32 v113, v34, v35
    v_or_b32 v113, v113, v27
    v_cvt_pk_bf16_f32 v114, v36, v37
    v_or_b32 v114, v114, v27
    v_cvt_pk_bf16_f32 v115, v38, v39
    v_or_b32 v115, v115, v27
    v_cvt_pk_bf16_f32 v116, v40, v41
    s_add_u32 s73, s73, 229376
    v_or_b32 v116, v116, v27
    v_cvt_pk_bf16_f32 v117, v42, v43
    v_or_b32 v117, v117, v27
    v_cvt_pk_bf16_f32 v118, v44, v45
    v_or_b32 v118, v118, v27
    v_cvt_pk_bf16_f32 v119, v46, v47
    s_add_u32 m0, s70, 98304
    v_or_b32 v119, v119, v27
    v_cvt_pk_bf16_f32 v96, v96, v97
    v_cvt_pk_bf16_f32 v97, v98, v99
    v_cvt_pk_bf16_f32 v98, v100, v101
    v_cvt_pk_bf16_f32 v99, v102, v103
    v_cvt_pk_bf16_f32 v100, v104, v105
    v_cvt_pk_bf16_f32 v101, v106, v107
    buffer_load_dwordx4 v95, s[20:23], s73 offen lds
    v_cvt_pk_bf16_f32 v102, v108, v109
    v_cvt_pk_bf16_f32 v103, v110, v111
    v_mfma_f32_32x32x16_bf16 v[8:23], v[96:99], v[112:115], 0
    s_nop 0
    v_mfma_f32_32x32x16_bf16 v[8:23], v[100:103], v[116:119], v[8:23]
    v_cvt_pk_bf16_f32 v120, v48, v49
    v_cvt_pk_bf16_f32 v121, v50, v51
    v_cvt_pk_bf16_f32 v122, v52, v53
    s_add_u32 s73, s73, 229376
    v_cvt_pk_bf16_f32 v123, v54, v55
    s_nop 1
    v_mfma_f32_32x32x16_bf16 v[96:111], v[72:75], v[120:123], 0
    v_mul_f32 v56, v56, v87
    v_mul_f32 v57, v57, v87
    v_mul_f32 v58, v58, v87
    v_mul_f32 v59, v59, v87
    s_add_u32 m0, s70, 106496
    v_mul_f32 v60, v60, v87
    v_mul_f32 v61, v61, v87
    v_mul_f32 v62, v62, v87
    v_mul_f32 v63, v63, v87
    v_cvt_pk_bf16_f32 v120, v56, v57
    v_cvt_pk_bf16_f32 v121, v58, v59
    v_cvt_pk_bf16_f32 v122, v60, v61
    buffer_load_dwordx4 v95, s[20:23], s73 offen lds
    v_cvt_pk_bf16_f32 v123, v62, v63
    s_nop 1
    v_mfma_f32_32x32x16_bf16 v[48:63], v[120:123], v[64:67], 0
    v_max3_f32 v2, v96, v97, v98
    v_max3_f32 v3, -v96, -v97, -v98
    v_max3_f32 v2, v2, v99, v100
    v_max3_f32 v3, v3, -v99, -v100
    v_max3_f32 v2, v2, v101, v102
    s_add_u32 s73, s73, 229376
    v_max3_f32 v3, v3, -v101, -v102
    v_max_f32 v2, v2, v103
    v_max_f32_e64 v3, v3, -v103
    s_nop 1
    v_permlane32_swap_b32 v2, v3
    v_max_f32 v2, v2, v3
    v_mul_f32_e64 v2, -v2, v88
    v_mov_b32 v3, v2
    s_nop 1
    v_permlane32_swap_b32 v2, v3
    v_fma_f32 v112, -v96, v88, v3
    v_fma_f32 v96, v96, v88, v2
    v_fma_f32 v113, -v97, v88, v3
    v_fma_f32 v97, v97, v88, v2
    v_fma_f32 v114, -v98, v88, v3
    v_fma_f32 v98, v98, v88, v2
    v_fma_f32 v115, -v99, v88, v3
    v_fma_f32 v99, v99, v88, v2
    v_fma_f32 v116, -v100, v88, v3
    v_fma_f32 v100, v100, v88, v2
    v_fma_f32 v117, -v101, v88, v3
    v_fma_f32 v101, v101, v88, v2
    v_fma_f32 v118, -v102, v88, v3
    v_fma_f32 v102, v102, v88, v2
    v_fma_f32 v119, -v103, v88, v3
    v_fma_f32 v103, v103, v88, v2
    v_exp_f32 v112, v112
    v_exp_f32 v96, v96
    v_exp_f32 v113, v113
    v_exp_f32 v97, v97
    v_exp_f32 v114, v114
    v_exp_f32 v98, v98
    v_exp_f32 v115, v115
    v_exp_f32 v99, v99
    v_exp_f32 v116, v116
    v_exp_f32 v100, v100
    v_exp_f32 v117, v117
    v_exp_f32 v101, v101
    v_exp_f32 v118, v118
    v_exp_f32 v102, v102
    v_exp_f32 v119, v119
    v_exp_f32 v103, v103
    v_add_f32 v2, v96, v97
    v_add_f32 v3, v112, v113
    v_add_f32 v2, v2, v98
    v_add_f32 v3, v3, v114
    v_add_f32 v2, v2, v99
    v_add_f32 v3, v3, v115
    v_add_f32 v2, v2, v100
    v_add_f32 v3, v3, v116
    v_add_f32 v2, v2, v101
    v_add_f32 v3, v3, v117
    v_add_f32 v2, v2, v102
    v_add_f32 v3, v3, v118
    v_add_f32 v2, v2, v103
    v_add_f32 v3, v3, v119
    s_nop 1
    v_permlane32_swap_b32 v2, v3
    v_add_f32 v2, v2, v3
    v_rcp_f32 v2, v2
    s_nop 0
    v_mov_b32 v3, v2
    s_nop 1
    v_permlane32_swap_b32 v2, v3
    v_mul_f32 v96, v96, v2
    v_mul_f32 v112, v112, v3
    v_mul_f32 v97, v97, v2
    v_mul_f32 v113, v113, v3
    v_mul_f32 v98, v98, v2
    v_mul_f32 v114, v114, v3
    v_mul_f32 v99, v99, v2
    v_mul_f32 v115, v115, v3
    v_mul_f32 v100, v100, v2
    v_mul_f32 v116, v116, v3
    v_mul_f32 v101, v101, v2
    v_mul_f32 v117, v117, v3
    v_mul_f32 v102, v102, v2
    v_mul_f32 v118, v118, v3
    v_mul_f32 v103, v103, v2
    v_mul_f32 v119, v119, v3
    v_cvt_pk_bf16_f32 v120, v96, v97
    v_cvt_pk_bf16_f32 v124, v112, v113
    v_cvt_pk_bf16_f32 v121, v98, v99
    v_cvt_pk_bf16_f32 v125, v114, v115
    v_cvt_pk_bf16_f32 v122, v100, v101
    v_cvt_pk_bf16_f32 v126, v116, v117
    v_cvt_pk_bf16_f32 v123, v102, v103
    v_cvt_pk_bf16_f32 v127, v118, v119
    s_nop 0
    v_mfma_f32_32x32x16_bf16 v[96:111], v[120:123], v[64:67], 0
    v_mfma_f32_32x32x16_bf16 v[96:111], v[124:127], v[68:71], v[96:111]
    v_cvt_pk_bf16_f32 v112, v48, v49
    v_or_b32 v112, v112, v27
    v_cvt_pk_bf16_f32 v113, v50, v51
    v_or_b32 v113, v113, v27
    v_cvt_pk_bf16_f32 v114, v52, v53
    v_or_b32 v114, v114, v27
    v_cvt_pk_bf16_f32 v115, v54, v55
    v_or_b32 v115, v115, v27
    v_cvt_pk_bf16_f32 v116, v56, v57
    v_or_b32 v116, v116, v27
    v_cvt_pk_bf16_f32 v117, v58, v59
    v_or_b32 v117, v117, v27
    v_cvt_pk_bf16_f32 v118, v60, v61
    v_or_b32 v118, v118, v27
    v_cvt_pk_bf16_f32 v119, v62, v63
    v_or_b32 v119, v119, v27
    v_cvt_pk_bf16_f32 v96, v96, v97
    v_cvt_pk_bf16_f32 v97, v98, v99
    v_cvt_pk_bf16_f32 v98, v100, v101
    v_cvt_pk_bf16_f32 v99, v102, v103
    v_cvt_pk_bf16_f32 v100, v104, v105
    v_cvt_pk_bf16_f32 v101, v106, v107
    v_cvt_pk_bf16_f32 v102, v108, v109
    v_cvt_pk_bf16_f32 v103, v110, v111
    v_mfma_f32_32x32x16_bf16 v[8:23], v[96:99], v[112:115], v[8:23]
    s_nop 0
    v_mfma_f32_32x32x16_bf16 v[8:23], v[100:103], v[116:119], v[8:23]
    s_lshl_b32 s9, s63, 12
    s_lshl_b32 s10, s7, 11
    s_add_u32 s9, s9, s10
    s_add_u32 s9, s9, 32768
    v_add_u32 v92, s9, v26
    v_xor_b32 v93, 0x800, v92
    v_mul_u32_u24 v94, 17, v30
    v_add_u32 v94, v94, v29
    v_lshlrev_b32 v94, 2, v94
    s_mul_i32 s10, s63, 2176
    s_mul_i32 s11, s7, 1088
    s_add_u32 s10, s10, s11
    s_add_u32 s10, s10, s72
    v_cmp_gt_u32 s[80:81], 17, v29
    s_cmp_eq_u32 s7, 0
    s_cbranch_scc1 L_kv0
    ds_write_b128 v92, v[8:11] offset:0
    ds_write_b128 v92, v[12:15] offset:1024
    v_mov_b32 v8, v16
    v_mov_b32 v9, v17
    v_mov_b32 v10, v18
    v_mov_b32 v11, v19
    v_mov_b32 v12, v20
    v_mov_b32 v13, v21
    v_mov_b32 v14, v22
    v_mov_b32 v15, v23
    s_branch L_kv1
L_kv0:
    ds_write_b128 v92, v[16:19] offset:0
    ds_write_b128 v92, v[20:23] offset:1024
L_kv1:
    s_waitcnt vmcnt(0)
    s_waitcnt lgkmcnt(0)
    s_barrier
    ds_read_b128 v[96:99], v93 offset:0
    ds_read_b128 v[100:103], v93 offset:1024
    v_mov_b32 v18, v90
    v_mov_b32 v19, 0
    v_add_u32 v20, 49152, v91
    s_waitcnt lgkmcnt(0)
    v_add_f32 v8, v8, v96
    v_add_f32 v9, v9, v97
    v_add_f32 v10, v10, v98
    v_add_f32 v11, v11, v99
    v_add_f32 v12, v12, v100
    v_add_f32 v13, v13, v101
    v_add_f32 v14, v14, v102
    v_add_f32 v15, v15, v103
    s_mov_b64 exec, s[80:81]
    buffer_atomic_add_f32 v8, v94, s[24:27], s10 offen offset:0
    buffer_atomic_add_f32 v9, v94, s[24:27], s10 offen offset:136
    buffer_atomic_add_f32 v10, v94, s[24:27], s10 offen offset:272
    buffer_atomic_add_f32 v11, v94, s[24:27], s10 offen offset:408
    buffer_atomic_add_f32 v12, v94, s[24:27], s10 offen offset:544
    buffer_atomic_add_f32 v13, v94, s[24:27], s10 offen offset:680
    buffer_atomic_add_f32 v14, v94, s[24:27], s10 offen offset:816
    buffer_atomic_add_f32 v15, v94, s[24:27], s10 offen offset:952
    s_mov_b64 exec, -1
    v_mfma_f32_32x32x16_bf16 v[32:47], v[4:7], v[76:79], 0
    ds_read_b64_tr_b16 v[48:49], v20 offset:0
    ds_read_b64_tr_b16 v[50:51], v20 offset:512
    ds_read_b64_tr_b16 v[52:53], v20 offset:2048
    ds_read_b64_tr_b16 v[54:55], v20 offset:2560
    ds_read_b64_tr_b16 v[56:57], v20 offset:4096
    ds_read_b64_tr_b16 v[58:59], v20 offset:4608
    s_add_u32 s81, s61, 81920
    s_sub_u32 s9, s81, 229376
    s_cmp_ge_u32 s81, s83
    s_cselect_b32 s81, s9, s81
    ds_read_b64_tr_b16 v[60:61], v20 offset:6144
    ds_read_b64_tr_b16 v[62:63], v20 offset:6656
    s_waitcnt lgkmcnt(6)
    v_mfma_f32_32x32x16_bf16 v[32:47], v[48:51], v[128:131], v[32:47]
    ds_read_b64_tr_b16 v[48:49], v20 offset:8192
    ds_read_b64_tr_b16 v[50:51], v20 offset:8704
    s_waitcnt lgkmcnt(6)
    v_mfma_f32_32x32x16_bf16 v[32:47], v[52:55], v[132:135], v[32:47]
    ds_read_b64_tr_b16 v[52:53], v20 offset:10240
    ds_read_b64_tr_b16 v[54:55], v20 offset:10752
    s_waitcnt lgkmcnt(6)
    v_mfma_f32_32x32x16_bf16 v[32:47], v[56:59], v[136:139], v[32:47]
    ds_read_b64_tr_b16 v[56:57], v20 offset:12288
    ds_read_b64_tr_b16 v[58:59], v20 offset:12800
    s_waitcnt lgkmcnt(6)
    v_mfma_f32_32x32x16_bf16 v[32:47], v[60:63], v[140:143], v[32:47]
    ds_read_b64_tr_b16 v[60:61], v20 offset:14336
    ds_read_b64_tr_b16 v[62:63], v20 offset:14848
    s_waitcnt lgkmcnt(6)
    v_mfma_f32_32x32x16_bf16 v[32:47], v[48:51], v[144:147], v[32:47]
    ds_read_b64_tr_b16 v[48:49], v20 offset:16384
    ds_read_b64_tr_b16 v[50:51], v20 offset:16896
    s_waitcnt lgkmcnt(6)
    v_mfma_f32_32x32x16_bf16 v[32:47], v[52:55], v[148:151], v[32:47]
    ds_read_b64_tr_b16 v[52:53], v20 offset:18432
    ds_read_b64_tr_b16 v[54:55], v20 offset:18944
    s_waitcnt lgkmcnt(6)
    v_mfma_f32_32x32x16_bf16 v[32:47], v[56:59], v[152:155], v[32:47]
    ds_read_b64_tr_b16 v[56:57], v20 offset:20480
    ds_read_b64_tr_b16 v[58:59], v20 offset:20992
    s_waitcnt lgkmcnt(6)
    v_mfma_f32_32x32x16_bf16 v[32:47], v[60:63], v[156:159], v[32:47]
    ds_read_b64_tr_b16 v[60:61], v20 offset:22528
    ds_read_b64_tr_b16 v[62:63], v20 offset:23040
    s_waitcnt lgkmcnt(6)
    v_mfma_f32_32x32x16_bf16 v[32:47], v[48:51], v[160:163], v[32:47]
    ds_read_b64_tr_b16 v[48:49], v20 offset:24576
    ds_read_b64_tr_b16 v[50:51], v20 offset:25088
    s_waitcnt lgkmcnt(6)
    v_mfma_f32_32x32x16_bf16 v[32:47], v[52:55], v[164:167], v[32:47]
    ds_read_b64_tr_b16 v[52:53], v20 offset:26624
    ds_read_b64_tr_b16 v[54:55], v20 offset:27136
    s_waitcnt lgkmcnt(6)
    v_mfma_f32_32x32x16_bf16 v[32:47], v[56:59], v[168:171], v[32:47]
    ds_read_b64_tr_b16 v[56:57], v20 offset:28672
    ds_read_b64_tr_b16 v[58:59], v20 offset:29184
    s_waitcnt lgkmcnt(6)
    v_mfma_f32_32x32x16_bf16 v[32:47], v[60:63], v[172:175], v[32:47]
    ds_read_b64_tr_b16 v[60:61], v20 offset:30720
    ds_read_b64_tr_b16 v[62:63], v20 offset:31232
    s_waitcnt lgkmcnt(6)
    v_mfma_f32_32x32x16_bf16 v[32:47], v[48:51], v[176:179], v[32:47]
    ds_read_b64_tr_b16 v[48:49], v20 offset:32768
    ds_read_b64_tr_b16 v[50:51], v20 offset:33280
    s_waitcnt lgkmcnt(6)
    v_mfma_f32_32x32x16_bf16 v[32:47], v[52:55], v[180:183], v[32:47]
    ds_read_b64_tr_b16 v[52:53], v20 offset:34816
    ds_read_b64_tr_b16 v[54:55], v20 offset:35328
    s_waitcnt lgkmcnt(6)
    v_mfma_f32_32x32x16_bf16 v[32:47], v[56:59], v[184:187], v[32:47]
    ds_read_b64_tr_b16 v[56:57], v20 offset:36864
    ds_read_b64_tr_b16 v[58:59], v20 offset:37376
    s_waitcnt lgkmcnt(6)
    v_mfma_f32_32x32x16_bf16 v[32:47], v[60:63], v[188:191], v[32:47]
    ds_read_b64_tr_b16 v[60:61], v20 offset:38912
    ds_read_b64_tr_b16 v[62:63], v20 offset:39424
    s_waitcnt lgkmcnt(6)
    v_mfma_f32_32x32x16_bf16 v[32:47], v[48:51], v[192:195], v[32:47]
    ds_read_b64_tr_b16 v[48:49], v20 offset:40960
    ds_read_b64_tr_b16 v[50:51], v20 offset:41472
    s_waitcnt lgkmcnt(6)
    v_mfma_f32_32x32x16_bf16 v[32:47], v[52:55], v[196:199], v[32:47]
    ds_read_b64_tr_b16 v[52:53], v20 offset:43008
    ds_read_b64_tr_b16 v[54:55], v20 offset:43520
    s_waitcnt lgkmcnt(6)
    v_mfma_f32_32x32x16_bf16 v[32:47], v[56:59], v[200:203], v[32:47]
    ds_read_b64_tr_b16 v[56:57], v20 offset:45056
    ds_read_b64_tr_b16 v[58:59], v20 offset:45568
    s_waitcnt lgkmcnt(6)
    v_mfma_f32_32x32x16_bf16 v[32:47], v[60:63], v[204:207], v[32:47]
    ds_read_b64_tr_b16 v[60:61], v20 offset:47104
    ds_read_b64_tr_b16 v[62:63], v20 offset:47616
    s_waitcnt lgkmcnt(6)
    v_mfma_f32_32x32x16_bf16 v[32:47], v[48:51], v[208:211], v[32:47]
    s_waitcnt vmcnt(0)
    s_lshl_b32 s9, s6, 9
    s_lshl_b32 s10, s4, 5
    s_add_u32 s9, s9, s10
    s_lshl_b32 s10, s3, 2
    s_add_u32 s9, s9, s10
    s_add_u32 s9, s9, 9510912
    v_mov_b32 v31, s75
    s_mov_b64 exec, 1
    buffer_store_dword v31, v19, s[24:27], s9 offen sc1
    s_mov_b64 exec, -1
    ds_read_b64_tr_b16 v[48:49], v20 offset:49152
    ds_read_b64_tr_b16 v[50:51], v20 offset:49664
    s_waitcnt lgkmcnt(6)
    v_mfma_f32_32x32x16_bf16 v[32:47], v[52:55], v[212:215], v[32:47]
    ds_read_b64_tr_b16 v[52:53], v20 offset:51200
    ds_read_b64_tr_b16 v[54:55], v20 offset:51712
    s_waitcnt lgkmcnt(6)
    v_mfma_f32_32x32x16_bf16 v[32:47], v[56:59], v[216:219], v[32:47]
    ds_read_b64_tr_b16 v[56:57], v20 offset:53248
    ds_read_b64_tr_b16 v[58:59], v20 offset:53760
    s_waitcnt lgkmcnt(6)
    v_mfma_f32_32x32x16_bf16 v[32:47], v[60:63], v[220:223], v[32:47]
    ds_read_b64_tr_b16 v[60:61], v20 offset:55296
    ds_read_b64_tr_b16 v[62:63], v20 offset:55808
    s_waitcnt lgkmcnt(6)
    v_mfma_f32_32x32x16_bf16 v[32:47], v[48:51], v[224:227], v[32:47]
    ds_read_b64_tr_b16 v[48:49], v20 offset:57344
    ds_read_b64_tr_b16 v[50:51], v20 offset:57856
    s_waitcnt lgkmcnt(6)
    v_mfma_f32_32x32x16_bf16 v[32:47], v[52:55], v[228:231], v[32:47]
    ds_read_b64_tr_b16 v[52:53], v20 offset:59392
    ds_read_b64_tr_b16 v[54:55], v20 offset:59904
    s_waitcnt lgkmcnt(6)
    v_mfma_f32_32x32x16_bf16 v[32:47], v[56:59], v[232:235], v[32:47]
    ds_read_b64_tr_b16 v[56:57], v20 offset:61440
    ds_read_b64_tr_b16 v[58:59], v20 offset:61952
    s_waitcnt lgkmcnt(6)
    v_mfma_f32_32x32x16_bf16 v[32:47], v[60:63], v[236:239], v[32:47]
    ds_read_b64_tr_b16 v[60:61], v20 offset:63488
    ds_read_b64_tr_b16 v[62:63], v20 offset:64000
    s_waitcnt lgkmcnt(6)
    v_mfma_f32_32x32x16_bf16 v[32:47], v[48:51], v[240:243], v[32:47]
    s_waitcnt lgkmcnt(4)
    v_mfma_f32_32x32x16_bf16 v[32:47], v[52:55], v[244:247], v[32:47]
    s_waitcnt lgkmcnt(2)
    v_mfma_f32_32x32x16_bf16 v[32:47], v[56:59], v[248:251], v[32:47]
    s_waitcnt lgkmcnt(0)
    v_mfma_f32_32x32x16_bf16 v[32:47], v[60:63], v[252:255], v[32:47]
    s_lshl_b32 s9, s67, 11
    s_add_u32 s9, s9, s74
    s_nop 9
    v_add_f32_e64 v32, v32, |v32|
    v_add_f32_e64 v33, v33, |v33|
    v_add_f32_e64 v34, v34, |v34|
    v_add_f32_e64 v35, v35, |v35|
    v_add_f32_e64 v36, v36, |v36|
    v_add_f32_e64 v37, v37, |v37|
    v_add_f32_e64 v38, v38, |v38|
    v_add_f32_e64 v39, v39, |v39|
    v_add_f32_e64 v40, v40, |v40|
    v_add_f32_e64 v41, v41, |v41|
    v_add_f32_e64 v42, v42, |v42|
    v_add_f32_e64 v43, v43, |v43|
    v_add_f32_e64 v44, v44, |v44|
    v_add_f32_e64 v45, v45, |v45|
    v_add_f32_e64 v46, v46, |v46|
    v_add_f32_e64 v47, v47, |v47|
    v_mul_f32 v32, v32, v86
    v_mul_f32 v33, v33, v86
    v_mul_f32 v34, v34, v86
    v_mul_f32 v35, v35, v86
    v_mul_f32 v36, v36, v86
    v_mul_f32 v37, v37, v86
    v_mul_f32 v38, v38, v86
    v_mul_f32 v39, v39, v86
    v_mul_f32 v40, v40, v86
    v_mul_f32 v41, v41, v86
    v_mul_f32 v42, v42, v86
    v_mul_f32 v43, v43, v86
    v_mul_f32 v44, v44, v86
    v_mul_f32 v45, v45, v86
    v_mul_f32 v46, v46, v86
    v_mul_f32 v47, v47, v86
    v_mul_f32 v32, v32, v32
    v_mul_f32 v33, v33, v33
    v_mul_f32 v34, v34, v34
    v_mul_f32 v35, v35, v35
    v_mul_f32 v36, v36, v36
    v_mul_f32 v37, v37, v37
    v_mul_f32 v38, v38, v38
    v_mul_f32 v39, v39, v39
    v_mul_f32 v40, v40, v40
    v_mul_f32 v41, v41, v41
    v_mul_f32 v42, v42, v42
    v_mul_f32 v43, v43, v43
    v_mul_f32 v44, v44, v44
    v_mul_f32 v45, v45, v45
    v_mul_f32 v46, v46, v46
    v_mul_f32 v47, v47, v47
    v_cvt_pk_bf16_f32 v32, v32, v33
    v_cvt_pk_bf16_f32 v33, v34, v35
    v_cvt_pk_bf16_f32 v34, v36, v37
    v_cvt_pk_bf16_f32 v35, v38, v39
    v_cvt_pk_bf16_f32 v36, v40, v41
    v_cvt_pk_bf16_f32 v37, v42, v43
    v_cvt_pk_bf16_f32 v38, v44, v45
    v_cvt_pk_bf16_f32 v39, v46, v47
    buffer_store_dwordx4 v[32:35], v26, s[24:27], s9 offen sc1
    buffer_store_dwordx4 v[36:39], v26, s[24:27], s9 offen offset:1024 sc1
    v_lshrrev_b32 v8, 5, v1
    v_bfe_u32 v9, v1, 2, 2
    v_lshl_add_u32 v8, v8, 2, v9
    v_lshlrev_b32 v8, 7, v8
    v_and_b32 v10, 3, v1
    v_lshl_add_u32 v8, v10, 3, v8
    v_bfe_u32 v10, v1, 4, 1
    v_and_b32 v9, 2, v9
    v_or_b32 v10, v10, v9
    v_lshl_add_u32 v2, v10, 5, v8
    v_add_u32 v2, s69, v2
    v_xor_b32 v3, 64, v2
    v_add_u32 v4, 0x10000, v2
    v_add_u32 v5, 0x10000, v3
    v_add_u32 v6, 0x20000, v2
    v_add_u32 v7, 0x20000, v3
    ds_read_b64_tr_b16 v[128:129], v4 offset:49152
    ds_read_b64_tr_b16 v[130:131], v4 offset:50176
    ds_read_b64_tr_b16 v[132:133], v5 offset:49152
    ds_read_b64_tr_b16 v[134:135], v5 offset:50176
    ds_read_b64_tr_b16 v[136:137], v6 offset:0
    ds_read_b64_tr_b16 v[138:139], v6 offset:1024
    ds_read_b64_tr_b16 v[140:141], v7 offset:0
    ds_read_b64_tr_b16 v[142:143], v7 offset:1024
    ds_read_b64_tr_b16 v[144:145], v6 offset:16384
    ds_read_b64_tr_b16 v[146:147], v6 offset:17408
    ds_read_b64_tr_b16 v[148:149], v7 offset:16384
    ds_read_b64_tr_b16 v[150:151], v7 offset:17408
    ds_read_b64_tr_b16 v[152:153], v2 offset:16384
    ds_read_b64_tr_b16 v[154:155], v2 offset:17408
    ds_read_b64_tr_b16 v[156:157], v3 offset:16384
    ds_read_b64_tr_b16 v[158:159], v3 offset:17408
    s_barrier
    s_add_u32 m0, s69, 32768
    s_add_u32 s71, s61, 8192
    buffer_load_dwordx4 v18, s[44:47], s61 offen lds
    s_add_u32 m0, s69, 33792
    s_nop 0
    buffer_load_dwordx4 v18, s[44:47], s71 offen lds
    s_add_u32 s61, s61, 16384
    s_cmp_eq_u32 s61, s83
    s_cselect_b32 s61, s60, s61
    s_add_u32 m0, s69, 49152
    s_add_u32 s71, s61, 8192
    buffer_load_dwordx4 v18, s[44:47], s61 offen lds
    s_add_u32 m0, s69, 50176
    s_nop 0
    buffer_load_dwordx4 v18, s[44:47], s71 offen lds
    s_add_u32 s61, s61, 16384
    s_cmp_eq_u32 s61, s83
    s_cselect_b32 s61, s60, s61
    s_waitcnt vmcnt(4)
    s_lshl_b32 s9, s4, 1
    s_add_u32 s9, s9, s7
    s_lshl_b32 s77, s9, 8
    s_lshl_b32 s10, s79, 2
    s_add_u32 s10, s10, s63
    s_lshl_b32 s10, s10, 2
    s_add_u32 s9, s77, s10
    s_add_u32 s9, s9, 9515008
    v_mov_b32 v31, s75
    s_mov_b64 exec, 1
    buffer_store_dword v31, v19, s[24:27], s9 offen sc1
    s_mov_b64 exec, -1
    s_barrier
    s_add_u32 m0, s69, 65536
    s_add_u32 s71, s61, 8192
    buffer_load_dwordx4 v18, s[44:47], s61 offen lds
    s_add_u32 m0, s69, 66560
    s_nop 0
    buffer_load_dwordx4 v18, s[44:47], s71 offen lds
    s_add_u32 s61, s61, 16384
    s_cmp_eq_u32 s61, s83
    s_cselect_b32 s61, s60, s61
    s_add_u32 m0, s69, 81920
    s_add_u32 s71, s61, 8192
    buffer_load_dwordx4 v18, s[44:47], s61 offen lds
    s_add_u32 m0, s69, 82944
    s_nop 0
    buffer_load_dwordx4 v18, s[44:47], s71 offen lds
    s_add_u32 s61, s61, 16384
    s_cmp_eq_u32 s61, s83
    s_cselect_b32 s61, s60, s61
    s_add_u32 m0, s69, 98304
    s_add_u32 s71, s61, 8192
    buffer_load_dwordx4 v18, s[44:47], s61 offen lds
    s_add_u32 m0, s69, 99328
    s_nop 0
    buffer_load_dwordx4 v18, s[44:47], s71 offen lds
    s_add_u32 s61, s61, 16384
    s_cmp_eq_u32 s61, s83
    s_cselect_b32 s61, s60, s61
    s_waitcnt lgkmcnt(0)
    s_add_u32 m0, s69, 114688
    s_add_u32 s71, s81, 0
    buffer_load_dwordx4 v18, s[44:47], s71 offen lds
    s_add_u32 m0, s69, 115712
    s_add_u32 s71, s81, 8192
    buffer_load_dwordx4 v18, s[44:47], s71 offen lds
    s_add_u32 s81, s81, 16384
    s_cmp_eq_u32 s81, s83
    s_cselect_b32 s81, s60, s81
    s_add_u32 m0, s69, 131072
    s_add_u32 s71, s81, 0
    buffer_load_dwordx4 v18, s[44:47], s71 offen lds
    s_add_u32 m0, s69, 132096
    s_add_u32 s71, s81, 8192
    buffer_load_dwordx4 v18, s[44:47], s71 offen lds
    s_add_u32 s81, s81, 16384
    s_cmp_eq_u32 s81, s83
    s_cselect_b32 s81, s60, s81
    s_add_u32 m0, s69, 147456
    s_add_u32 s71, s81, 0
    buffer_load_dwordx4 v18, s[44:47], s71 offen lds
    s_add_u32 m0, s69, 148480
    s_add_u32 s71, s81, 8192
    buffer_load_dwordx4 v18, s[44:47], s71 offen lds
    s_add_u32 s81, s81, 16384
    s_cmp_eq_u32 s81, s83
    s_cselect_b32 s81, s60, s81
    s_add_u32 m0, s69, 16384
    s_add_u32 s71, s81, 0
    buffer_load_dwordx4 v18, s[44:47], s71 offen lds
    s_add_u32 m0, s69, 17408
    s_add_u32 s71, s81, 8192
    buffer_load_dwordx4 v18, s[44:47], s71 offen lds
    s_add_u32 s81, s81, 16384
    s_cmp_eq_u32 s81, s83
    s_cselect_b32 s81, s60, s81
    s_waitcnt vmcnt(8)
    ds_read_b64_tr_b16 v[160:161], v2 offset:32768
    ds_read_b64_tr_b16 v[162:163], v2 offset:33792
    ds_read_b64_tr_b16 v[164:165], v3 offset:32768
    ds_read_b64_tr_b16 v[166:167], v3 offset:33792
    ds_read_b64_tr_b16 v[168:169], v2 offset:49152
    ds_read_b64_tr_b16 v[170:171], v2 offset:50176
    ds_read_b64_tr_b16 v[172:173], v3 offset:49152
    ds_read_b64_tr_b16 v[174:175], v3 offset:50176
    ds_read_b64_tr_b16 v[176:177], v4 offset:0
    ds_read_b64_tr_b16 v[178:179], v4 offset:1024
    ds_read_b64_tr_b16 v[180:181], v5 offset:0
    ds_read_b64_tr_b16 v[182:183], v5 offset:1024
    ds_read_b64_tr_b16 v[184:185], v4 offset:16384
    ds_read_b64_tr_b16 v[186:187], v4 offset:17408
    ds_read_b64_tr_b16 v[188:189], v5 offset:16384
    ds_read_b64_tr_b16 v[190:191], v5 offset:17408
    ds_read_b64_tr_b16 v[192:193], v4 offset:32768
    ds_read_b64_tr_b16 v[194:195], v4 offset:33792
    ds_read_b64_tr_b16 v[196:197], v5 offset:32768
    ds_read_b64_tr_b16 v[198:199], v5 offset:33792
    s_waitcnt lgkmcnt(0)
    s_add_u32 m0, s69, 32768
    s_add_u32 s71, s81, 0
    buffer_load_dwordx4 v18, s[44:47], s71 offen lds
    s_add_u32 m0, s69, 33792
    s_add_u32 s71, s81, 8192
    buffer_load_dwordx4 v18, s[44:47], s71 offen lds
    s_add_u32 s81, s81, 16384
    s_cmp_eq_u32 s81, s83
    s_cselect_b32 s81, s60, s81
    s_add_u32 m0, s69, 49152
    s_add_u32 s71, s68, 0
    buffer_load_dwordx4 v18, s[48:51], s71 offen lds
    s_add_u32 m0, s69, 50176
    s_add_u32 s71, s68, 8192
    buffer_load_dwordx4 v18, s[48:51], s71 offen lds
    s_add_u32 m0, s69, 65536
    s_add_u32 s71, s68, 16384
    buffer_load_dwordx4 v18, s[48:51], s71 offen lds
    s_add_u32 m0, s69, 66560
    s_add_u32 s71, s68, 24576
    buffer_load_dwordx4 v18, s[48:51], s71 offen lds
    s_add_u32 m0, s69, 81920
    s_add_u32 s71, s68, 32768
    buffer_load_dwordx4 v18, s[48:51], s71 offen lds
    s_add_u32 m0, s69, 82944
    s_add_u32 s71, s68, 40960
    buffer_load_dwordx4 v18, s[48:51], s71 offen lds
    s_add_u32 m0, s69, 98304
    s_add_u32 s71, s68, 49152
    buffer_load_dwordx4 v18, s[48:51], s71 offen lds
    s_add_u32 m0, s69, 99328
    s_add_u32 s71, s68, 57344
    buffer_load_dwordx4 v18, s[48:51], s71 offen lds
    s_branch L_tail
L_typeB:
    s_add_u32 m0, s69, 65408
    s_nop 0
    buffer_load_dwordx4 v2, s[12:15], s76 offen offset:128 lds
    s_add_u32 m0, s69, 66432
    s_nop 0
    buffer_load_dwordx4 v3, s[12:15], s76 offen offset:128 lds
    s_add_u32 m0, s70, 81920
    s_nop 0
    buffer_load_dwordx4 v4, s[16:19], s82 offen lds
    s_add_u32 s82, s82, 196608
    s_add_u32 m0, s70, 90112
    s_nop 0
    buffer_load_dwordx4 v5, s[40:43], s83 offen lds
    s_add_u32 s83, s83, s75
    s_add_u32 m0, s70, 98304
    s_nop 0
    buffer_load_dwordx4 v6, s[20:23], s73 offen lds
    s_add_u32 m0, s70, 106496
    s_nop 0
    buffer_load_dwordx4 v7, s[20:23], s73 offen lds
    s_add_u32 s73, s73, 229376
    v_add_u32 v160, 98304, v8
    v_add_u32 v161, 98304, v9
    v_add_u32 v162, 98304, v10
    v_add_u32 v163, 98304, v11
    v_add_u32 v164, 98304, v12
    v_add_u32 v165, 98304, v13
    v_add_u32 v166, 98304, v14
    v_add_u32 v167, 98304, v15
    v_add_u32 v168, 98304, v16
    v_add_u32 v169, 98304, v17
    s_cmp_eq_u32 s8, 0
    s_cselect_b64 s[80:81], -1, 0
    s_mov_b64 vcc, s[80:81]
    s_waitcnt vmcnt(10)
    s_barrier
    ds_read_b128 v[96:99], v8 offset:0
    ds_read_b64_tr_b16 v[104:105], v16 offset:0
    ds_read_b64_tr_b16 v[106:107], v16 offset:512
    ds_read_b128 v[100:103], v12 offset:0
    ds_read_b64_tr_b16 v[108:109], v17 offset:0
    ds_read_b64_tr_b16 v[110:111], v17 offset:512
    s_waitcnt lgkmcnt(0)
    ds_read_b128 v[112:115], v9 offset:0
    ds_read_b64_tr_b16 v[120:121], v16 offset:2048
    ds_read_b64_tr_b16 v[122:123], v16 offset:2560
    ds_read_b128 v[116:119], v13 offset:0
    ds_read_b64_tr_b16 v[124:125], v17 offset:2048
    ds_read_b64_tr_b16 v[126:127], v17 offset:2560
    v_mfma_f32_32x32x16_bf16 v[32:47], v[104:107], v[96:99], 0
    v_mfma_f32_32x32x16_bf16 v[48:63], v[104:107], v[100:103], 0
    s_add_u32 m0, s69, 114432
    s_nop 0
    buffer_load_dwordx4 v2, s[12:15], s76 offen offset:256 lds
    s_add_u32 m0, s69, 115456
    s_nop 0
    buffer_load_dwordx4 v3, s[12:15], s76 offen offset:256 lds
    v_mfma_f32_32x32x16_bf16 v[64:79], v[108:111], v[96:99], 0
    s_cbranch_vccz L_m4_0
    v_mfma_f32_32x32x16_bf16 v[80:95], v[108:111], v[100:103], 0
L_m4_0:
    s_cmp_lt_u32 s3, 2
    s_cbranch_scc0 L_nowpB
    s_add_u32 m0, s70, 14336
    s_lshl_b32 s9, s6, 11
    s_add_u32 s9, s9, s70
    buffer_load_dwordx4 v26, s[32:35], s9 offen lds
L_nowpB:
    s_waitcnt lgkmcnt(0)
    ds_read_b128 v[96:99], v10 offset:0
    ds_read_b64_tr_b16 v[104:105], v16 offset:4096
    ds_read_b64_tr_b16 v[106:107], v16 offset:4608
    ds_read_b128 v[100:103], v14 offset:0
    ds_read_b64_tr_b16 v[108:109], v17 offset:4096
    ds_read_b64_tr_b16 v[110:111], v17 offset:4608
    v_mfma_f32_32x32x16_bf16 v[32:47], v[120:123], v[112:115], v[32:47]
    v_mfma_f32_32x32x16_bf16 v[48:63], v[120:123], v[116:119], v[48:63]
    s_add_u32 m0, s70, 131072
    s_nop 0
    buffer_load_dwordx4 v4, s[16:19], s82 offen lds
    s_add_u32 s82, s82, 196608
    s_add_u32 m0, s70, 139264
    s_nop 0
    buffer_load_dwordx4 v5, s[40:43], s83 offen lds
    s_add_u32 s83, s83, s75
    v_mfma_f32_32x32x16_bf16 v[64:79], v[124:127], v[112:115], v[64:79]
    s_cbranch_vccz L_m4_1
    v_mfma_f32_32x32x16_bf16 v[80:95], v[124:127], v[116:119], v[80:95]
L_m4_1:
    s_waitcnt lgkmcnt(0)
    ds_read_b128 v[112:115], v11 offset:0
    ds_read_b64_tr_b16 v[120:121], v16 offset:6144
    ds_read_b64_tr_b16 v[122:123], v16 offset:6656
    ds_read_b128 v[116:119], v15 offset:0
    ds_read_b64_tr_b16 v[124:125], v17 offset:6144
    ds_read_b64_tr_b16 v[126:127], v17 offset:6656
    v_mfma_f32_32x32x16_bf16 v[32:47], v[104:107], v[96:99], v[32:47]
    v_mfma_f32_32x32x16_bf16 v[48:63], v[104:107], v[100:103], v[48:63]
    s_add_u32 m0, s70, 147456
    s_nop 0
    buffer_load_dwordx4 v6, s[20:23], s73 offen lds
    s_add_u32 m0, s70, 155648
    s_nop 0
    buffer_load_dwordx4 v7, s[20:23], s73 offen lds
    s_add_u32 s73, s73, 229376
    v_mfma_f32_32x32x16_bf16 v[64:79], v[108:111], v[96:99], v[64:79]
    s_cbranch_vccz L_m4_2
    v_mfma_f32_32x32x16_bf16 v[80:95], v[108:111], v[100:103], v[80:95]
L_m4_2:
    s_waitcnt lgkmcnt(0)
    s_waitcnt vmcnt(6)
    s_barrier
    ds_read_b128 v[96:99], v8 offset:49152
    ds_read_b64_tr_b16 v[104:105], v16 offset:49152
    ds_read_b64_tr_b16 v[106:107], v16 offset:49664
    ds_read_b128 v[100:103], v12 offset:49152
    ds_read_b64_tr_b16 v[108:109], v17 offset:49152
    ds_read_b64_tr_b16 v[110:111], v17 offset:49664
    v_mfma_f32_32x32x16_bf16 v[32:47], v[120:123], v[112:115], v[32:47]
    v_mfma_f32_32x32x16_bf16 v[48:63], v[120:123], v[116:119], v[48:63]
    s_add_u32 m0, s69, 16000
    s_nop 0
    buffer_load_dwordx4 v2, s[12:15], s76 offen offset:384 lds
    s_add_u32 m0, s69, 17024
    s_nop 0
    buffer_load_dwordx4 v3, s[12:15], s76 offen offset:384 lds
    v_mfma_f32_32x32x16_bf16 v[64:79], v[124:127], v[112:115], v[64:79]
    s_cbranch_vccz L_m4_3
    v_mfma_f32_32x32x16_bf16 v[80:95], v[124:127], v[116:119], v[80:95]
L_m4_3:
    s_cmp_eq_u32 s3, 0
    s_cbranch_scc0 L_noflB
    s_mov_b32 s71, 0
L_nspinB:
    v_readfirstlane_b32 s9, v31
    s_add_u32 s71, s71, 1
    s_cmp_gt_u32 s71, 60000
    s_cbranch_scc1 L_nokB
    s_cmp_lg_u32 s9, 0
    s_cbranch_scc1 L_nokB
    buffer_load_dword v31, v19, s[28:31], 0 offen sc1
    s_waitcnt vmcnt(0)
    s_branch L_nspinB
L_nokB:
    s_lshl_b32 s10, s4, 7
    s_lshl_b32 s11, s79, 2
    s_add_u32 s10, s10, s11
    s_lshl_b32 s11, s79, 7
    s_lshl_b32 s71, s4, 2
    s_add_u32 s11, s11, s71
    s_add_u32 s11, s11, 2048
    v_mov_b32 v240, s10
    v_writelane_b32 v240, s11, 1
    s_mov_b32 s10, 9531392
    s_mov_b64 exec, 3
    buffer_store_dword v31, v240, s[24:27], s10 offen sc1
    s_mov_b64 exec, -1
L_noflB:
    s_waitcnt lgkmcnt(0)
    ds_read_b128 v[112:115], v9 offset:49152
    ds_read_b64_tr_b16 v[120:121], v16 offset:51200
    ds_read_b64_tr_b16 v[122:123], v16 offset:51712
    ds_read_b128 v[116:119], v13 offset:49152
    ds_read_b64_tr_b16 v[124:125], v17 offset:51200
    ds_read_b64_tr_b16 v[126:127], v17 offset:51712
    v_mfma_f32_32x32x16_bf16 v[32:47], v[104:107], v[96:99], v[32:47]
    v_mfma_f32_32x32x16_bf16 v[48:63], v[104:107], v[100:103], v[48:63]
    s_add_u32 m0, s70, 32768
    s_nop 0
    buffer_load_dwordx4 v4, s[16:19], s82 offen lds
    s_add_u32 s82, s82, 196608
    s_add_u32 m0, s70, 40960
    s_nop 0
    buffer_load_dwordx4 v5, s[40:43], s83 offen lds
    s_add_u32 s83, s83, s75
    v_mfma_f32_32x32x16_bf16 v[64:79], v[108:111], v[96:99], v[64:79]
    s_cbranch_vccz L_m4_4
    v_mfma_f32_32x32x16_bf16 v[80:95], v[108:111], v[100:103], v[80:95]
L_m4_4:
    s_waitcnt lgkmcnt(0)
    ds_read_b128 v[96:99], v10 offset:49152
    ds_read_b64_tr_b16 v[104:105], v16 offset:53248
    ds_read_b64_tr_b16 v[106:107], v16 offset:53760
    ds_read_b128 v[100:103], v14 offset:49152
    ds_read_b64_tr_b16 v[108:109], v17 offset:53248
    ds_read_b64_tr_b16 v[110:111], v17 offset:53760
    v_mfma_f32_32x32x16_bf16 v[32:47], v[120:123], v[112:115], v[32:47]
    v_mfma_f32_32x32x16_bf16 v[48:63], v[120:123], v[116:119], v[48:63]
    s_add_u32 m0, s70, 49152
    s_nop 0
    buffer_load_dwordx4 v6, s[20:23], s73 offen lds
    v_mfma_f32_32x32x16_bf16 v[64:79], v[124:127], v[112:115], v[64:79]
    s_cbranch_vccz L_m4_5
    v_mfma_f32_32x32x16_bf16 v[80:95], v[124:127], v[116:119], v[80:95]
L_m4_5:
    s_waitcnt lgkmcnt(0)
    ds_read_b128 v[112:115], v11 offset:49152
    ds_read_b64_tr_b16 v[120:121], v16 offset:55296
    ds_read_b64_tr_b16 v[122:123], v16 offset:55808
    ds_read_b128 v[116:119], v15 offset:49152
    ds_read_b64_tr_b16 v[124:125], v17 offset:55296
    ds_read_b64_tr_b16 v[126:127], v17 offset:55808
    v_mfma_f32_32x32x16_bf16 v[32:47], v[104:107], v[96:99], v[32:47]
    v_mfma_f32_32x32x16_bf16 v[48:63], v[104:107], v[100:103], v[48:63]
    s_add_u32 m0, s70, 57344
    s_nop 0
    buffer_load_dwordx4 v7, s[20:23], s73 offen lds
    s_add_u32 s73, s73, 229376
    v_mfma_f32_32x32x16_bf16 v[64:79], v[108:111], v[96:99], v[64:79]
    s_cbranch_vccz L_m4_6
    v_mfma_f32_32x32x16_bf16 v[80:95], v[108:111], v[100:103], v[80:95]
L_m4_6:
    s_waitcnt lgkmcnt(0)
    s_waitcnt vmcnt(6)
    s_barrier
    ds_read_b128 v[96:99], v160 offset:0
    ds_read_b64_tr_b16 v[104:105], v168 offset:0
    ds_read_b64_tr_b16 v[106:107], v168 offset:512
    ds_read_b128 v[100:103], v164 offset:0
    ds_read_b64_tr_b16 v[108:109], v169 offset:0
    ds_read_b64_tr_b16 v[110:111], v169 offset:512
    v_mfma_f32_32x32x16_bf16 v[32:47], v[120:123], v[112:115], v[32:47]
    v_mfma_f32_32x32x16_bf16 v[48:63], v[120:123], v[116:119], v[48:63]
    s_add_u32 m0, s69, 65024
    s_nop 0
    buffer_load_dwordx4 v2, s[12:15], s76 offen offset:512 lds
    s_add_u32 m0, s69, 66048
    s_nop 0
    buffer_load_dwordx4 v3, s[12:15], s76 offen offset:512 lds
    v_mfma_f32_32x32x16_bf16 v[64:79], v[124:127], v[112:115], v[64:79]
    s_cbranch_vccz L_m4_7
    v_mfma_f32_32x32x16_bf16 v[80:95], v[124:127], v[116:119], v[80:95]
L_m4_7:
    s_waitcnt lgkmcnt(0)
    ds_read_b128 v[112:115], v161 offset:0
    ds_read_b64_tr_b16 v[120:121], v168 offset:2048
    ds_read_b64_tr_b16 v[122:123], v168 offset:2560
    ds_read_b128 v[116:119], v165 offset:0
    ds_read_b64_tr_b16 v[124:125], v169 offset:2048
    ds_read_b64_tr_b16 v[126:127], v169 offset:2560
    v_mfma_f32_32x32x16_bf16 v[32:47], v[104:107], v[96:99], v[32:47]
    v_mfma_f32_32x32x16_bf16 v[48:63], v[104:107], v[100:103], v[48:63]
    s_add_u32 m0, s70, 81920
    s_nop 0
    buffer_load_dwordx4 v4, s[16:19], s82 offen lds
    s_add_u32 s82, s82, 196608
    s_add_u32 m0, s70, 90112
    s_nop 0
    buffer_load_dwordx4 v5, s[40:43], s83 offen lds
    s_add_u32 s83, s83, s75
    v_mfma_f32_32x32x16_bf16 v[64:79], v[108:111], v[96:99], v[64:79]
    s_cbranch_vccz L_m4_8
    v_mfma_f32_32x32x16_bf16 v[80:95], v[108:111], v[100:103], v[80:95]
L_m4_8:
    s_cmp_lt_u32 s3, 6
    s_cbranch_scc1 L_sl3B
    s_lshr_b32 s9, s2, 3
    v_lshlrev_b32 v250, 10, v1
    s_cmp_eq_u32 s3, 6
    s_cbranch_scc1 L_sl1B
    s_lshr_b32 s10, s44, 7
    s_sub_u32 s10, 3, s10
    s_and_b32 s10, s10, 7
    s_lshl_b32 s10, s10, 7
    s_mul_i32 s9, s9, 57344
    s_add_u32 s9, s9, s10
    s_mov_b32 exec_hi, 0xffffff
    buffer_load_dword v250, v250, s[44:47], s9 offen
    s_branch L_sl2B
L_sl1B:
    s_lshr_b32 s10, s48, 7
    s_sub_u32 s10, 3, s10
    s_and_b32 s10, s10, 7
    s_lshl_b32 s10, s10, 7
    s_lshl_b32 s9, s9, 14
    s_add_u32 s9, s9, s10
    s_mov_b64 exec, 0xffff
    buffer_load_dword v250, v250, s[48:51], s9 offen
L_sl2B:
    s_mov_b64 exec, -1
L_sl3B:
    ds_read_b64_tr_b16 v[200:201], v21 offset:0
    ds_read_b64_tr_b16 v[202:203], v21 offset:256
    ds_read_b64_tr_b16 v[204:205], v21 offset:512
    ds_read_b64_tr_b16 v[206:207], v21 offset:768
    s_waitcnt lgkmcnt(0)
    ds_read_b128 v[96:99], v162 offset:0
    ds_read_b64_tr_b16 v[104:105], v168 offset:4096
    ds_read_b64_tr_b16 v[106:107], v168 offset:4608
    ds_read_b128 v[100:103], v166 offset:0
    ds_read_b64_tr_b16 v[108:109], v169 offset:4096
    ds_read_b64_tr_b16 v[110:111], v169 offset:4608
    v_mfma_f32_32x32x16_bf16 v[32:47], v[120:123], v[112:115], v[32:47]
    v_mfma_f32_32x32x16_bf16 v[48:63], v[120:123], v[116:119], v[48:63]
    s_add_u32 m0, s70, 98304
    s_nop 0
    buffer_load_dwordx4 v6, s[20:23], s73 offen lds
    v_mfma_f32_32x32x16_bf16 v[64:79], v[124:127], v[112:115], v[64:79]
    s_cbranch_vccz L_m4_9
    v_mfma_f32_32x32x16_bf16 v[80:95], v[124:127], v[116:119], v[80:95]
L_m4_9:
    s_waitcnt lgkmcnt(0)
    ds_read_b128 v[112:115], v163 offset:0
    ds_read_b64_tr_b16 v[120:121], v168 offset:6144
    ds_read_b64_tr_b16 v[122:123], v168 offset:6656
    ds_read_b128 v[116:119], v167 offset:0
    ds_read_b64_tr_b16 v[124:125], v169 offset:6144
    ds_read_b64_tr_b16 v[126:127], v169 offset:6656
    v_mfma_f32_32x32x16_bf16 v[32:47], v[104:107], v[96:99], v[32:47]
    v_mfma_f32_32x32x16_bf16 v[48:63], v[104:107], v[100:103], v[48:63]
    s_add_u32 m0, s70, 106496
    s_nop 0
    buffer_load_dwordx4 v7, s[20:23], s73 offen lds
    s_add_u32 s73, s73, 229376
    v_mfma_f32_32x32x16_bf16 v[64:79], v[108:111], v[96:99], v[64:79]
    s_cbranch_vccz L_m4_10
    v_mfma_f32_32x32x16_bf16 v[80:95], v[108:111], v[100:103], v[80:95]
L_m4_10:
    s_waitcnt lgkmcnt(0)
    s_waitcnt vmcnt(6)
    s_barrier
    ds_read_b128 v[96:99], v8 offset:0
    ds_read_b64_tr_b16 v[104:105], v16 offset:0
    ds_read_b64_tr_b16 v[106:107], v16 offset:512
    ds_read_b128 v[100:103], v12 offset:0
    ds_read_b64_tr_b16 v[108:109], v17 offset:0
    ds_read_b64_tr_b16 v[110:111], v17 offset:512
    v_mfma_f32_32x32x16_bf16 v[32:47], v[120:123], v[112:115], v[32:47]
    v_mfma_f32_32x32x16_bf16 v[48:63], v[120:123], v[116:119], v[48:63]
    s_add_u32 m0, s69, 114048
    s_nop 0
    buffer_load_dwordx4 v2, s[12:15], s76 offen offset:640 lds
    s_add_u32 m0, s69, 115072
    s_nop 0
    buffer_load_dwordx4 v3, s[12:15], s76 offen offset:640 lds
    v_mfma_f32_32x32x16_bf16 v[64:79], v[124:127], v[112:115], v[64:79]
    s_cbranch_vccz L_m4_11
    v_mfma_f32_32x32x16_bf16 v[80:95], v[124:127], v[116:119], v[80:95]
L_m4_11:
    s_waitcnt lgkmcnt(0)
    ds_read_b128 v[112:115], v9 offset:0
    ds_read_b64_tr_b16 v[120:121], v16 offset:2048
    ds_read_b64_tr_b16 v[122:123], v16 offset:2560
    ds_read_b128 v[116:119], v13 offset:0
    ds_read_b64_tr_b16 v[124:125], v17 offset:2048
    ds_read_b64_tr_b16 v[126:127], v17 offset:2560
    v_mfma_f32_32x32x16_bf16 v[32:47], v[104:107], v[96:99], v[32:47]
    v_mfma_f32_32x32x16_bf16 v[48:63], v[104:107], v[100:103], v[48:63]
    s_add_u32 m0, s70, 131072
    s_nop 0
    buffer_load_dwordx4 v4, s[16:19], s82 offen lds
    s_add_u32 s82, s82, 196608
    s_add_u32 m0, s70, 139264
    s_nop 0
    buffer_load_dwordx4 v5, s[40:43], s83 offen lds
    s_add_u32 s83, s83, s75
    v_mfma_f32_32x32x16_bf16 v[64:79], v[108:111], v[96:99], v[64:79]
    s_cbranch_vccz L_m4_12
    v_mfma_f32_32x32x16_bf16 v[80:95], v[108:111], v[100:103], v[80:95]
L_m4_12:
    s_waitcnt lgkmcnt(0)
    ds_read_b128 v[96:99], v10 offset:0
    ds_read_b64_tr_b16 v[104:105], v16 offset:4096
    ds_read_b64_tr_b16 v[106:107], v16 offset:4608
    ds_read_b128 v[100:103], v14 offset:0
    ds_read_b64_tr_b16 v[108:109], v17 offset:4096
    ds_read_b64_tr_b16 v[110:111], v17 offset:4608
    v_mfma_f32_32x32x16_bf16 v[32:47], v[120:123], v[112:115], v[32:47]
    v_mfma_f32_32x32x16_bf16 v[48:63], v[120:123], v[116:119], v[48:63]
    s_add_u32 m0, s70, 147456
    s_nop 0
    buffer_load_dwordx4 v6, s[20:23], s73 offen lds
    v_mfma_f32_32x32x16_bf16 v[64:79], v[124:127], v[112:115], v[64:79]
    s_cbranch_vccz L_m4_13
    v_mfma_f32_32x32x16_bf16 v[80:95], v[124:127], v[116:119], v[80:95]
L_m4_13:
    s_cmp_eq_u32 s3, 0
    s_cbranch_scc0 L_npiB
    buffer_load_dword v18, v25, s[24:27], 0 offen sc1
L_npiB:
    s_waitcnt lgkmcnt(0)
    ds_read_b128 v[112:115], v11 offset:0
    ds_read_b64_tr_b16 v[120:121], v16 offset:6144
    ds_read_b64_tr_b16 v[122:123], v16 offset:6656
    ds_read_b128 v[116:119], v15 offset:0
    ds_read_b64_tr_b16 v[124:125], v17 offset:6144
    ds_read_b64_tr_b16 v[126:127], v17 offset:6656
    v_mfma_f32_32x32x16_bf16 v[32:47], v[104:107], v[96:99], v[32:47]
    v_mfma_f32_32x32x16_bf16 v[48:63], v[104:107], v[100:103], v[48:63]
    s_add_u32 m0, s70, 155648
    s_nop 0
    buffer_load_dwordx4 v7, s[20:23], s73 offen lds
    s_add_u32 s73, s73, 229376
    v_mfma_f32_32x32x16_bf16 v[64:79], v[108:111], v[96:99], v[64:79]
    s_cbranch_vccz L_m4_14
    v_mfma_f32_32x32x16_bf16 v[80:95], v[108:111], v[100:103], v[80:95]
L_m4_14:
    s_waitcnt lgkmcnt(0)
    s_waitcnt vmcnt(6)
    s_barrier
    ds_read_b128 v[96:99], v8 offset:49152
    ds_read_b64_tr_b16 v[104:105], v16 offset:49152
    ds_read_b64_tr_b16 v[106:107], v16 offset:49664
    ds_read_b128 v[100:103], v12 offset:49152
    ds_read_b64_tr_b16 v[108:109], v17 offset:49152
    ds_read_b64_tr_b16 v[110:111], v17 offset:49664
    v_mfma_f32_32x32x16_bf16 v[32:47], v[120:123], v[112:115], v[32:47]
    v_mfma_f32_32x32x16_bf16 v[48:63], v[120:123], v[116:119], v[48:63]
    s_add_u32 m0, s69, 15616
    s_nop 0
    buffer_load_dwordx4 v2, s[12:15], s76 offen offset:768 lds
    s_add_u32 m0, s69, 16640
    s_nop 0
    buffer_load_dwordx4 v3, s[12:15], s76 offen offset:768 lds
    v_mfma_f32_32x32x16_bf16 v[64:79], v[124:127], v[112:115], v[64:79]
    s_cbranch_vccz L_m4_15
    v_mfma_f32_32x32x16_bf16 v[80:95], v[124:127], v[116:119], v[80:95]
L_m4_15:
    s_waitcnt lgkmcnt(0)
    ds_read_b128 v[112:115], v9 offset:49152
    ds_read_b64_tr_b16 v[120:121], v16 offset:51200
    ds_read_b64_tr_b16 v[122:123], v16 offset:51712
    ds_read_b128 v[116:119], v13 offset:49152
    ds_read_b64_tr_b16 v[124:125], v17 offset:51200
    ds_read_b64_tr_b16 v[126:127], v17 offset:51712
    v_mfma_f32_32x32x16_bf16 v[32:47], v[104:107], v[96:99], v[32:47]
    v_mfma_f32_32x32x16_bf16 v[48:63], v[104:107], v[100:103], v[48:63]
    s_add_u32 m0, s70, 32768
    s_nop 0
    buffer_load_dwordx4 v4, s[16:19], s82 offen lds
    s_add_u32 s82, s82, 196608
    s_add_u32 m0, s70, 40960
    s_nop 0
    buffer_load_dwordx4 v5, s[40:43], s83 offen lds
    s_add_u32 s83, s83, s75
    v_mfma_f32_32x32x16_bf16 v[64:79], v[108:111], v[96:99], v[64:79]
    s_cbranch_vccz L_m4_16
    v_mfma_f32_32x32x16_bf16 v[80:95], v[108:111], v[100:103], v[80:95]
L_m4_16:
    s_waitcnt lgkmcnt(0)
    ds_read_b128 v[96:99], v10 offset:49152
    ds_read_b64_tr_b16 v[104:105], v16 offset:53248
    ds_read_b64_tr_b16 v[106:107], v16 offset:53760
    ds_read_b128 v[100:103], v14 offset:49152
    ds_read_b64_tr_b16 v[108:109], v17 offset:53248
    ds_read_b64_tr_b16 v[110:111], v17 offset:53760
    v_mfma_f32_32x32x16_bf16 v[32:47], v[120:123], v[112:115], v[32:47]
    v_mfma_f32_32x32x16_bf16 v[48:63], v[120:123], v[116:119], v[48:63]
    s_add_u32 m0, s70, 49152
    s_nop 0
    buffer_load_dwordx4 v6, s[20:23], s73 offen lds
    v_mfma_f32_32x32x16_bf16 v[64:79], v[124:127], v[112:115], v[64:79]
    s_cbranch_vccz L_m4_17
    v_mfma_f32_32x32x16_bf16 v[80:95], v[124:127], v[116:119], v[80:95]
L_m4_17:
    s_waitcnt lgkmcnt(0)
    ds_read_b128 v[112:115], v11 offset:49152
    ds_read_b64_tr_b16 v[120:121], v16 offset:55296
    ds_read_b64_tr_b16 v[122:123], v16 offset:55808
    ds_read_b128 v[116:119], v15 offset:49152
    ds_read_b64_tr_b16 v[124:125], v17 offset:55296
    ds_read_b64_tr_b16 v[126:127], v17 offset:55808
    v_mfma_f32_32x32x16_bf16 v[32:47], v[104:107], v[96:99], v[32:47]
    v_mfma_f32_32x32x16_bf16 v[48:63], v[104:107], v[100:103], v[48:63]
    s_add_u32 m0, s70, 57344
    s_nop 0
    buffer_load_dwordx4 v7, s[20:23], s73 offen lds
    s_add_u32 s73, s73, 229376
    v_mfma_f32_32x32x16_bf16 v[64:79], v[108:111], v[96:99], v[64:79]
    s_cbranch_vccz L_m4_18
    v_mfma_f32_32x32x16_bf16 v[80:95], v[108:111], v[100:103], v[80:95]
L_m4_18:
    s_waitcnt lgkmcnt(0)
    s_waitcnt vmcnt(6)
    s_cmp_eq_u32 s3, 0
    s_cbranch_scc0 L_fok2B
    s_mov_b32 s71, 0
L_fspinB:
    v_cmp_ne_u32 vcc, v18, v31
    s_cmp_eq_u64 vcc, 0
    s_cbranch_scc1 L_fokB
    s_add_u32 s71, s71, 1
    s_cmp_gt_u32 s71, 60000
    s_cbranch_scc1 L_fokB
    s_sleep 8
    buffer_load_dword v18, v25, s[24:27], 0 offen sc1
    s_waitcnt vmcnt(0)
    s_branch L_fspinB
L_fokB:
    s_mov_b64 vcc, s[80:81]
    ds_write_b32 v19, v31 offset:16380
    s_waitcnt lgkmcnt(0)
L_fok2B:
    s_barrier
    ds_read_b128 v[96:99], v160 offset:0
    ds_read_b64_tr_b16 v[104:105], v168 offset:0
    ds_read_b64_tr_b16 v[106:107], v168 offset:512
    ds_read_b128 v[100:103], v164 offset:0
    ds_read_b64_tr_b16 v[108:109], v169 offset:0
    ds_read_b64_tr_b16 v[110:111], v169 offset:512
    v_mfma_f32_32x32x16_bf16 v[32:47], v[120:123], v[112:115], v[32:47]
    v_mfma_f32_32x32x16_bf16 v[48:63], v[120:123], v[116:119], v[48:63]
    s_add_u32 m0, s69, 64640
    s_nop 0
    buffer_load_dwordx4 v2, s[12:15], s76 offen offset:896 lds
    s_add_u32 m0, s69, 65664
    s_nop 0
    buffer_load_dwordx4 v3, s[12:15], s76 offen offset:896 lds
    v_mfma_f32_32x32x16_bf16 v[64:79], v[124:127], v[112:115], v[64:79]
    s_cbranch_vccz L_m4_19
    v_mfma_f32_32x32x16_bf16 v[80:95], v[124:127], v[116:119], v[80:95]
L_m4_19:
    ds_read_b32 v31, v19 offset:16380
    v_lshlrev_b32 v240, 4, v29
    s_lshl_b32 s9, s4, 11
    s_lshl_b32 s10, s62, 9
    s_add_u32 s9, s9, s10
    s_add_u32 s9, s9, 9764864
    s_xor_b32 s10, s9, 512
    s_cmp_lt_u32 s3, 7
    s_cbranch_scc0 L_nocsdB
    s_mul_i32 s11, s79, 14336
    s_add_u32 s11, s11, s69
    s_add_u32 s11, s11, 9535488
    s_mov_b32 m0, s69
    s_nop 0
    buffer_load_dwordx4 v26, s[24:27], s11 offen sc1 lds
    buffer_load_dwordx4 v26, s[24:27], s11 offen offset:1024 sc1 lds
L_nocsdB:
    buffer_load_dwordx4 v[232:235], v240, s[24:27], s9 offen sc1
    buffer_load_dwordx4 v[236:239], v240, s[24:27], s10 offen sc1
    s_waitcnt lgkmcnt(0)
    ds_read_b128 v[112:115], v161 offset:0
    ds_read_b64_tr_b16 v[120:121], v168 offset:2048
    ds_read_b64_tr_b16 v[122:123], v168 offset:2560
    ds_read_b128 v[116:119], v165 offset:0
    ds_read_b64_tr_b16 v[124:125], v169 offset:2048
    ds_read_b64_tr_b16 v[126:127], v169 offset:2560
    v_mfma_f32_32x32x16_bf16 v[32:47], v[104:107], v[96:99], v[32:47]
    v_mfma_f32_32x32x16_bf16 v[48:63], v[104:107], v[100:103], v[48:63]
    s_add_u32 m0, s70, 81920
    s_nop 0
    buffer_load_dwordx4 v4, s[16:19], s82 offen lds
    s_add_u32 s82, s82, 196608
    s_add_u32 m0, s70, 90112
    s_nop 0
    buffer_load_dwordx4 v5, s[40:43], s83 offen lds
    s_add_u32 s83, s83, s75
    v_mfma_f32_32x32x16_bf16 v[64:79], v[108:111], v[96:99], v[64:79]
    s_cbranch_vccz L_m4_20
    v_mfma_f32_32x32x16_bf16 v[80:95], v[108:111], v[100:103], v[80:95]
L_m4_20:
    s_waitcnt lgkmcnt(0)
    ds_read_b128 v[96:99], v162 offset:0
    ds_read_b64_tr_b16 v[104:105], v168 offset:4096
    ds_read_b64_tr_b16 v[106:107], v168 offset:4608
    ds_read_b128 v[100:103], v166 offset:0
    ds_read_b64_tr_b16 v[108:109], v169 offset:4096
    ds_read_b64_tr_b16 v[110:111], v169 offset:4608
    v_mfma_f32_32x32x16_bf16 v[32:47], v[120:123], v[112:115], v[32:47]
    v_mfma_f32_32x32x16_bf16 v[48:63], v[120:123], v[116:119], v[48:63]
    s_add_u32 m0, s70, 98304
    s_nop 0
    buffer_load_dwordx4 v6, s[20:23], s73 offen lds
    v_mfma_f32_32x32x16_bf16 v[64:79], v[124:127], v[112:115], v[64:79]
    s_cbranch_vccz L_m4_21
    v_mfma_f32_32x32x16_bf16 v[80:95], v[124:127], v[116:119], v[80:95]
L_m4_21:
    s_waitcnt lgkmcnt(0)
    ds_read_b128 v[112:115], v163 offset:0
    ds_read_b64_tr_b16 v[120:121], v168 offset:6144
    ds_read_b64_tr_b16 v[122:123], v168 offset:6656
    ds_read_b128 v[116:119], v167 offset:0
    ds_read_b64_tr_b16 v[124:125], v169 offset:6144
    ds_read_b64_tr_b16 v[126:127], v169 offset:6656
    v_mfma_f32_32x32x16_bf16 v[32:47], v[104:107], v[96:99], v[32:47]
    v_mfma_f32_32x32x16_bf16 v[48:63], v[104:107], v[100:103], v[48:63]
    s_add_u32 m0, s70, 106496
    s_nop 0
    buffer_load_dwordx4 v7, s[20:23], s73 offen lds
    s_add_u32 s73, s73, 229376
    v_mfma_f32_32x32x16_bf16 v[64:79], v[108:111], v[96:99], v[64:79]
    s_cbranch_vccz L_m4_22
    v_mfma_f32_32x32x16_bf16 v[80:95], v[108:111], v[100:103], v[80:95]
L_m4_22:
    v_readfirstlane_b32 s75, v31
    v_lshrrev_b32 v240, 3, v1
    v_and_b32 v241, 7, v1
    v_lshrrev_b32 v242, 2, v1
    v_and_b32 v242, 4, v242
    v_xor_b32 v241, v241, v242
    v_lshlrev_b32 v240, 10, v240
    v_lshl_add_u32 v18, v241, 4, v240
    s_lshl_b32 s74, s4, 2
    s_add_u32 s74, s74, s62
    s_xor_b32 s64, s74, 1
    s_mul_i32 s74, s74, 147456
    s_mul_i32 s64, s64, 147456
    s_and_b32 s82, s2, 7
    s_lshl_b32 s82, s82, 2
    s_bfe_u32 s9, s2, 0x20003
    s_add_u32 s82, s82, s9
    s_lshr_b32 s62, s2, 5
    s_mul_i32 s76, s62, 7
    s_lshr_b32 s76, s76, 2
    s_mul_i32 s9, s9, 3
    s_add_u32 s76, s76, s9
    s_lshl_b32 s62, s62, 7
    s_mul_i32 s60, s3, 229376
    s_add_u32 s60, s60, s62
    s_add_u32 s83, s60, 229376
    s_lshl_b32 s68, s3, 16
    s_add_u32 s68, s68, s62
    s_cmp_ge_u32 s76, 14
    s_cselect_b32 s9, 14, 0
    s_sub_u32 s76, s76, s9
    s_lshl_b32 s61, s76, 14
    s_add_u32 s61, s61, s60
    s_waitcnt lgkmcnt(0)
    s_waitcnt vmcnt(8)
    s_barrier
    ds_read_b128 v[96:99], v8 offset:0
    ds_read_b64_tr_b16 v[104:105], v16 offset:0
    ds_read_b64_tr_b16 v[106:107], v16 offset:512
    ds_read_b128 v[100:103], v12 offset:0
    ds_read_b64_tr_b16 v[108:109], v17 offset:0
    ds_read_b64_tr_b16 v[110:111], v17 offset:512
    v_mfma_f32_32x32x16_bf16 v[32:47], v[120:123], v[112:115], v[32:47]
    v_mfma_f32_32x32x16_bf16 v[48:63], v[120:123], v[116:119], v[48:63]
    v_mfma_f32_32x32x16_bf16 v[64:79], v[124:127], v[112:115], v[64:79]
    s_cbranch_vccz L_m4_23
    v_mfma_f32_32x32x16_bf16 v[80:95], v[124:127], v[116:119], v[80:95]
L_m4_23:
    s_add_u32 m0, s69, 114688
    s_add_u32 s71, s61, 8192
    buffer_load_dwordx4 v18, s[44:47], s61 offen lds
    s_add_u32 m0, s69, 115712
    s_nop 0
    buffer_load_dwordx4 v18, s[44:47], s71 offen lds
    s_add_u32 s61, s61, 16384
    s_cmp_eq_u32 s61, s83
    s_cselect_b32 s61, s60, s61
    s_waitcnt lgkmcnt(0)
    ds_read_b128 v[112:115], v9 offset:0
    ds_read_b64_tr_b16 v[120:121], v16 offset:2048
    ds_read_b64_tr_b16 v[122:123], v16 offset:2560
    ds_read_b128 v[116:119], v13 offset:0
    ds_read_b64_tr_b16 v[124:125], v17 offset:2048
    ds_read_b64_tr_b16 v[126:127], v17 offset:2560
    v_mfma_f32_32x32x16_bf16 v[32:47], v[104:107], v[96:99], v[32:47]
    v_mfma_f32_32x32x16_bf16 v[48:63], v[104:107], v[100:103], v[48:63]
    v_mfma_f32_32x32x16_bf16 v[64:79], v[108:111], v[96:99], v[64:79]
    s_cbranch_vccz L_m4_24
    v_mfma_f32_32x32x16_bf16 v[80:95], v[108:111], v[100:103], v[80:95]
L_m4_24:
    s_add_u32 m0, s69, 131072
    s_add_u32 s71, s61, 8192
    buffer_load_dwordx4 v18, s[44:47], s61 offen lds
    s_add_u32 m0, s69, 132096
    s_nop 0
    buffer_load_dwordx4 v18, s[44:47], s71 offen lds
    s_add_u32 s61, s61, 16384
    s_cmp_eq_u32 s61, s83
    s_cselect_b32 s61, s60, s61
    s_waitcnt lgkmcnt(0)
    ds_read_b128 v[96:99], v10 offset:0
    ds_read_b64_tr_b16 v[104:105], v16 offset:4096
    ds_read_b64_tr_b16 v[106:107], v16 offset:4608
    ds_read_b128 v[100:103], v14 offset:0
    ds_read_b64_tr_b16 v[108:109], v17 offset:4096
    ds_read_b64_tr_b16 v[110:111], v17 offset:4608
    v_mfma_f32_32x32x16_bf16 v[32:47], v[120:123], v[112:115], v[32:47]
    v_mfma_f32_32x32x16_bf16 v[48:63], v[120:123], v[116:119], v[48:63]
    v_mfma_f32_32x32x16_bf16 v[64:79], v[124:127], v[112:115], v[64:79]
    s_cbranch_vccz L_m4_25
    v_mfma_f32_32x32x16_bf16 v[80:95], v[124:127], v[116:119], v[80:95]
L_m4_25:
    s_add_u32 m0, s69, 147456
    s_add_u32 s71, s61, 8192
    buffer_load_dwordx4 v18, s[44:47], s61 offen lds
    s_add_u32 m0, s69, 148480
    s_nop 0
    buffer_load_dwordx4 v18, s[44:47], s71 offen lds
    s_add_u32 s61, s61, 16384
    s_cmp_eq_u32 s61, s83
    s_cselect_b32 s61, s60, s61
    s_waitcnt lgkmcnt(0)
    ds_read_b128 v[112:115], v11 offset:0
    ds_read_b64_tr_b16 v[120:121], v16 offset:6144
    ds_read_b64_tr_b16 v[122:123], v16 offset:6656
    ds_read_b128 v[116:119], v15 offset:0
    ds_read_b64_tr_b16 v[124:125], v17 offset:6144
    ds_read_b64_tr_b16 v[126:127], v17 offset:6656
    v_mfma_f32_32x32x16_bf16 v[32:47], v[104:107], v[96:99], v[32:47]
    v_mfma_f32_32x32x16_bf16 v[48:63], v[104:107], v[100:103], v[48:63]
    v_mfma_f32_32x32x16_bf16 v[64:79], v[108:111], v[96:99], v[64:79]
    s_cbranch_vccz L_m4_26
    v_mfma_f32_32x32x16_bf16 v[80:95], v[108:111], v[100:103], v[80:95]
L_m4_26:
    s_waitcnt vmcnt(10)
    s_waitcnt lgkmcnt(0)
    s_waitcnt vmcnt(6)
    s_barrier
    ds_read_b128 v[96:99], v8 offset:49152
    ds_read_b64_tr_b16 v[104:105], v16 offset:49152
    ds_read_b64_tr_b16 v[106:107], v16 offset:49664
    ds_read_b128 v[100:103], v12 offset:49152
    ds_read_b64_tr_b16 v[108:109], v17 offset:49152
    ds_read_b64_tr_b16 v[110:111], v17 offset:49664
    v_mfma_f32_32x32x16_bf16 v[32:47], v[120:123], v[112:115], v[32:47]
    v_mfma_f32_32x32x16_bf16 v[48:63], v[120:123], v[116:119], v[48:63]
    v_mfma_f32_32x32x16_bf16 v[64:79], v[124:127], v[112:115], v[64:79]
    s_cbranch_vccz L_m4_27
    v_mfma_f32_32x32x16_bf16 v[80:95], v[124:127], v[116:119], v[80:95]
L_m4_27:
    s_add_u32 m0, s69, 16384
    s_add_u32 s71, s61, 8192
    buffer_load_dwordx4 v18, s[44:47], s61 offen lds
    s_add_u32 m0, s69, 17408
    s_nop 0
    buffer_load_dwordx4 v18, s[44:47], s71 offen lds
    s_add_u32 s61, s61, 16384
    s_cmp_eq_u32 s61, s83
    s_cselect_b32 s61, s60, s61
    s_waitcnt lgkmcnt(0)
    ds_read_b128 v[112:115], v9 offset:49152
    ds_read_b64_tr_b16 v[120:121], v16 offset:51200
    ds_read_b64_tr_b16 v[122:123], v16 offset:51712
    ds_read_b128 v[116:119], v13 offset:49152
    ds_read_b64_tr_b16 v[124:125], v17 offset:51200
    ds_read_b64_tr_b16 v[126:127], v17 offset:51712
    v_mfma_f32_32x32x16_bf16 v[32:47], v[104:107], v[96:99], v[32:47]
    v_mfma_f32_32x32x16_bf16 v[48:63], v[104:107], v[100:103], v[48:63]
    v_mfma_f32_32x32x16_bf16 v[64:79], v[108:111], v[96:99], v[64:79]
    s_cbranch_vccz L_m4_28
    v_mfma_f32_32x32x16_bf16 v[80:95], v[108:111], v[100:103], v[80:95]
L_m4_28:
    s_cmp_lt_u32 s3, 4
    s_cbranch_scc0 L_noredB
    v_min_u32 v240, 223, v0
    v_lshlrev_b32 v240, 2, v240
    ds_read_b32 v144, v240 offset:0
    ds_read_b32 v145, v240 offset:896
    ds_read_b32 v146, v240 offset:1792
    ds_read_b32 v147, v240 offset:2688
    ds_read_b32 v148, v240 offset:3584
    ds_read_b32 v149, v240 offset:4480
    ds_read_b32 v150, v240 offset:5376
    ds_read_b32 v151, v240 offset:6272
    ds_read_b32 v152, v240 offset:7168
    ds_read_b32 v153, v240 offset:8064
    ds_read_b32 v154, v240 offset:8960
    ds_read_b32 v155, v240 offset:9856
    ds_read_b32 v156, v240 offset:10752
    ds_read_b32 v157, v240 offset:11648
    ds_read_b32 v158, v240 offset:12544
    ds_read_b32 v159, v240 offset:13440
    s_waitcnt lgkmcnt(0)
    v_add_f32 v144, v144, v152
    v_add_f32 v145, v145, v153
    v_add_f32 v146, v146, v154
    v_add_f32 v147, v147, v155
    v_add_f32 v148, v148, v156
    v_add_f32 v149, v149, v157
    v_add_f32 v150, v150, v158
    v_add_f32 v151, v151, v159
    v_add_f32 v144, v144, v148
    v_add_f32 v145, v145, v149
    v_add_f32 v146, v146, v150
    v_add_f32 v147, v147, v151
    v_add_f32 v144, v144, v146
    v_add_f32 v145, v145, v147
    v_add_f32 v144, v144, v145
    v_cvt_pk_bf16_f32 v145, v144, v144
    v_and_b32 v145, 0xffff0000, v145
    v_sub_f32 v146, v144, v145
    v_cvt_pk_bf16_f32 v144, v145, v146
    ds_write_b32 v240, v144
L_noredB:
    s_waitcnt lgkmcnt(0)
    ds_read_b128 v[96:99], v10 offset:49152
    ds_read_b64_tr_b16 v[104:105], v16 offset:53248
    ds_read_b64_tr_b16 v[106:107], v16 offset:53760
    ds_read_b128 v[100:103], v14 offset:49152
    ds_read_b64_tr_b16 v[108:109], v17 offset:53248
    ds_read_b64_tr_b16 v[110:111], v17 offset:53760
    v_mfma_f32_32x32x16_bf16 v[32:47], v[120:123], v[112:115], v[32:47]
    v_mfma_f32_32x32x16_bf16 v[48:63], v[120:123], v[116:119], v[48:63]
    v_mfma_f32_32x32x16_bf16 v[64:79], v[124:127], v[112:115], v[64:79]
    s_cbranch_vccz L_m4_29
    v_mfma_f32_32x32x16_bf16 v[80:95], v[124:127], v[116:119], v[80:95]
L_m4_29:
    v_and_b32 v240, 0xffff, v232
    v_lshl_or_b32 v208, v240, 16, v240
    v_lshrrev_b32 v240, 16, v232
    v_lshl_or_b32 v209, v240, 16, v240
    v_mov_b32 v210, v233
    v_mov_b32 v211, 0
    v_mov_b32 v220, v234
    v_mul_f32 v221, 0x3fb8aa3b, v234
    v_mul_f32 v222, 0.5, v234
    v_and_b32 v240, 0xffff, v236
    v_lshl_or_b32 v212, v240, 16, v240
    v_lshrrev_b32 v240, 16, v236
    v_lshl_or_b32 v213, v240, 16, v240
    v_mov_b32 v214, v237
    v_mov_b32 v215, 0
    v_mov_b32 v223, v238
    v_mul_f32 v224, 0x3fb8aa3b, v238
    v_mul_f32 v225, 0.5, v238
    s_add_u32 m0, s69, 32768
    s_add_u32 s71, s61, 8192
    buffer_load_dwordx4 v18, s[44:47], s61 offen lds
    s_add_u32 m0, s69, 33792
    s_nop 0
    buffer_load_dwordx4 v18, s[44:47], s71 offen lds
    s_add_u32 s61, s61, 16384
    s_cmp_eq_u32 s61, s83
    s_cselect_b32 s61, s60, s61
    s_waitcnt lgkmcnt(0)
    ds_read_b128 v[112:115], v11 offset:49152
    ds_read_b64_tr_b16 v[120:121], v16 offset:55296
    ds_read_b64_tr_b16 v[122:123], v16 offset:55808
    ds_read_b128 v[116:119], v15 offset:49152
    ds_read_b64_tr_b16 v[124:125], v17 offset:55296
    ds_read_b64_tr_b16 v[126:127], v17 offset:55808
    v_mfma_f32_32x32x16_bf16 v[32:47], v[104:107], v[96:99], v[32:47]
    v_mfma_f32_32x32x16_bf16 v[48:63], v[104:107], v[100:103], v[48:63]
    v_mfma_f32_32x32x16_bf16 v[64:79], v[108:111], v[96:99], v[64:79]
    s_cbranch_vccz L_m4_30
    v_mfma_f32_32x32x16_bf16 v[80:95], v[108:111], v[100:103], v[80:95]
L_m4_30:
    s_add_u32 m0, s69, 49152
    s_add_u32 s71, s61, 8192
    buffer_load_dwordx4 v18, s[44:47], s61 offen lds
    s_add_u32 m0, s69, 50176
    s_nop 0
    buffer_load_dwordx4 v18, s[44:47], s71 offen lds
    s_add_u32 s61, s61, 16384
    s_cmp_eq_u32 s61, s83
    s_cselect_b32 s61, s60, s61
    s_waitcnt lgkmcnt(0)
    v_mfma_f32_32x32x16_bf16 v[32:47], v[120:123], v[112:115], v[32:47]
    v_mfma_f32_32x32x16_bf16 v[48:63], v[120:123], v[116:119], v[48:63]
    v_mfma_f32_32x32x16_bf16 v[64:79], v[124:127], v[112:115], v[64:79]
    s_cbranch_vccz L_m4_31
    v_mfma_f32_32x32x16_bf16 v[80:95], v[124:127], v[116:119], v[80:95]
L_m4_31:
    s_waitcnt lgkmcnt(0)
    s_barrier
    ds_read_b32 v216, v23
    ds_read_b32 v240, v24
    v_cmp_gt_u32 vcc, 32, v1
    v_lshl_or_b32 v27, v27, 16, v27
    v_lshl_or_b32 v28, v28, 16, v28
    s_and_b64 s[80:81], s[80:81], vcc
    v_cndmask_b32 v218, 0, v27, s[80:81]
    v_cndmask_b32 v242, 0, v28, vcc
    v_mov_b32 v219, 0
    v_mov_b32 v243, 0
    s_waitcnt lgkmcnt(0)
    v_cndmask_b32 v216, 0, v216, vcc
    v_cndmask_b32 v240, 0, v240, vcc
    v_mov_b32 v217, v216
    v_mov_b32 v241, v240
    s_nop 0
    v_mfma_f32_32x32x16_bf16 v[32:47], v[216:219], v[208:211], v[32:47]
    v_mfma_f32_32x32x16_bf16 v[48:63], v[216:219], v[212:215], v[48:63]
    v_mfma_f32_32x32x16_bf16 v[64:79], v[240:243], v[208:211], v[64:79]
    v_mfma_f32_32x32x16_bf16 v[80:95], v[240:243], v[212:215], v[80:95]
    s_add_u32 m0, s69, 65536
    s_add_u32 s71, s61, 8192
    buffer_load_dwordx4 v18, s[44:47], s61 offen lds
    s_add_u32 m0, s69, 66560
    s_nop 0
    buffer_load_dwordx4 v18, s[44:47], s71 offen lds
    s_add_u32 s61, s61, 16384
    s_cmp_eq_u32 s61, s83
    s_cselect_b32 s61, s60, s61
    s_add_u32 m0, s69, 81920
    s_add_u32 s71, s61, 8192
    buffer_load_dwordx4 v18, s[44:47], s61 offen lds
    s_add_u32 m0, s69, 82944
    s_nop 0
    buffer_load_dwordx4 v18, s[44:47], s71 offen lds
    s_add_u32 s61, s61, 16384
    s_cmp_eq_u32 s61, s83
    s_cselect_b32 s61, s60, s61
    s_add_u32 m0, s69, 98304
    s_add_u32 s71, s61, 8192
    buffer_load_dwordx4 v18, s[44:47], s61 offen lds
    s_add_u32 m0, s69, 99328
    s_nop 0
    buffer_load_dwordx4 v18, s[44:47], s71 offen lds
    s_add_u32 s61, s61, 16384
    s_cmp_eq_u32 s61, s83
    s_cselect_b32 s61, s60, s61
    v_lshrrev_b32 v8, 5, v1
    v_bfe_u32 v9, v1, 2, 2
    v_lshl_add_u32 v8, v8, 2, v9
    v_lshlrev_b32 v8, 7, v8
    v_and_b32 v10, 3, v1
    v_lshl_add_u32 v8, v10, 3, v8
    v_bfe_u32 v10, v1, 4, 1
    v_and_b32 v9, 2, v9
    v_or_b32 v10, v10, v9
    v_lshl_add_u32 v12, v10, 5, v8
    v_add_u32 v12, s69, v12
    v_xor_b32 v13, 64, v12
    v_add_u32 v14, 0x10000, v12
    v_add_u32 v15, 0x10000, v13
    v_add_u32 v16, 0x20000, v12
    v_add_u32 v17, 0x20000, v13
    s_cmp_eq_u32 s8, 0
    s_cbranch_scc0 L_Bq
    s_lshl_b32 s9, s66, 11
    s_add_u32 s9, s9, s74
    v_add_f32_e64 v32, v32, |v32|
    v_add_f32_e64 v33, v33, |v33|
    v_add_f32_e64 v34, v34, |v34|
    v_add_f32_e64 v35, v35, |v35|
    v_add_f32_e64 v36, v36, |v36|
    v_add_f32_e64 v37, v37, |v37|
    v_add_f32_e64 v38, v38, |v38|
    v_add_f32_e64 v39, v39, |v39|
    v_add_f32_e64 v40, v40, |v40|
    v_add_f32_e64 v41, v41, |v41|
    v_add_f32_e64 v42, v42, |v42|
    v_add_f32_e64 v43, v43, |v43|
    v_add_f32_e64 v44, v44, |v44|
    v_add_f32_e64 v45, v45, |v45|
    v_add_f32_e64 v46, v46, |v46|
    v_add_f32_e64 v47, v47, |v47|
    v_mul_f32 v32, v32, v222
    v_mul_f32 v33, v33, v222
    v_mul_f32 v34, v34, v222
    v_mul_f32 v35, v35, v222
    v_mul_f32 v36, v36, v222
    v_mul_f32 v37, v37, v222
    v_mul_f32 v38, v38, v222
    v_mul_f32 v39, v39, v222
    v_mul_f32 v40, v40, v222
    v_mul_f32 v41, v41, v222
    v_mul_f32 v42, v42, v222
    v_mul_f32 v43, v43, v222
    v_mul_f32 v44, v44, v222
    v_mul_f32 v45, v45, v222
    v_mul_f32 v46, v46, v222
    v_mul_f32 v47, v47, v222
    v_mul_f32 v32, v32, v32
    v_mul_f32 v33, v33, v33
    v_mul_f32 v34, v34, v34
    v_mul_f32 v35, v35, v35
    v_mul_f32 v36, v36, v36
    v_mul_f32 v37, v37, v37
    v_mul_f32 v38, v38, v38
    v_mul_f32 v39, v39, v39
    v_mul_f32 v40, v40, v40
    v_mul_f32 v41, v41, v41
    v_mul_f32 v42, v42, v42
    v_mul_f32 v43, v43, v43
    v_mul_f32 v44, v44, v44
    v_mul_f32 v45, v45, v45
    v_mul_f32 v46, v46, v46
    v_mul_f32 v47, v47, v47
    v_cvt_pk_bf16_f32 v32, v32, v33
    v_cvt_pk_bf16_f32 v33, v34, v35
    v_cvt_pk_bf16_f32 v34, v36, v37
    v_cvt_pk_bf16_f32 v35, v38, v39
    v_cvt_pk_bf16_f32 v36, v40, v41
    v_cvt_pk_bf16_f32 v37, v42, v43
    v_cvt_pk_bf16_f32 v38, v44, v45
    v_cvt_pk_bf16_f32 v39, v46, v47
    buffer_store_dwordx4 v[32:35], v26, s[24:27], s9 offen sc1
    buffer_store_dwordx4 v[36:39], v26, s[24:27], s9 offen offset:1024 sc1
    s_lshl_b32 s9, s66, 11
    s_add_u32 s9, s9, s64
    v_add_f32_e64 v48, v48, |v48|
    v_add_f32_e64 v49, v49, |v49|
    v_add_f32_e64 v50, v50, |v50|
    v_add_f32_e64 v51, v51, |v51|
    v_add_f32_e64 v52, v52, |v52|
    v_add_f32_e64 v53, v53, |v53|
    v_add_f32_e64 v54, v54, |v54|
    v_add_f32_e64 v55, v55, |v55|
    v_add_f32_e64 v56, v56, |v56|
    v_add_f32_e64 v57, v57, |v57|
    v_add_f32_e64 v58, v58, |v58|
    v_add_f32_e64 v59, v59, |v59|
    v_add_f32_e64 v60, v60, |v60|
    v_add_f32_e64 v61, v61, |v61|
    v_add_f32_e64 v62, v62, |v62|
    v_add_f32_e64 v63, v63, |v63|
    v_mul_f32 v48, v48, v225
    v_mul_f32 v49, v49, v225
    v_mul_f32 v50, v50, v225
    v_mul_f32 v51, v51, v225
    v_mul_f32 v52, v52, v225
    v_mul_f32 v53, v53, v225
    v_mul_f32 v54, v54, v225
    v_mul_f32 v55, v55, v225
    v_mul_f32 v56, v56, v225
    v_mul_f32 v57, v57, v225
    v_mul_f32 v58, v58, v225
    v_mul_f32 v59, v59, v225
    v_mul_f32 v60, v60, v225
    v_mul_f32 v61, v61, v225
    v_mul_f32 v62, v62, v225
    v_mul_f32 v63, v63, v225
    v_mul_f32 v48, v48, v48
    v_mul_f32 v49, v49, v49
    v_mul_f32 v50, v50, v50
    v_mul_f32 v51, v51, v51
    v_mul_f32 v52, v52, v52
    v_mul_f32 v53, v53, v53
    v_mul_f32 v54, v54, v54
    v_mul_f32 v55, v55, v55
    v_mul_f32 v56, v56, v56
    v_mul_f32 v57, v57, v57
    v_mul_f32 v58, v58, v58
    v_mul_f32 v59, v59, v59
    v_mul_f32 v60, v60, v60
    v_mul_f32 v61, v61, v61
    v_mul_f32 v62, v62, v62
    v_mul_f32 v63, v63, v63
    v_cvt_pk_bf16_f32 v48, v48, v49
    v_cvt_pk_bf16_f32 v49, v50, v51
    v_cvt_pk_bf16_f32 v50, v52, v53
    v_cvt_pk_bf16_f32 v51, v54, v55
    v_cvt_pk_bf16_f32 v52, v56, v57
    v_cvt_pk_bf16_f32 v53, v58, v59
    v_cvt_pk_bf16_f32 v54, v60, v61
    v_cvt_pk_bf16_f32 v55, v62, v63
    buffer_store_dwordx4 v[48:51], v26, s[24:27], s9 offen sc1
    buffer_store_dwordx4 v[52:55], v26, s[24:27], s9 offen offset:1024 sc1
    s_lshl_b32 s9, s67, 11
    s_add_u32 s9, s9, s74
    v_add_f32_e64 v64, v64, |v64|
    v_add_f32_e64 v65, v65, |v65|
    v_add_f32_e64 v66, v66, |v66|
    v_add_f32_e64 v67, v67, |v67|
    v_add_f32_e64 v68, v68, |v68|
    v_add_f32_e64 v69, v69, |v69|
    v_add_f32_e64 v70, v70, |v70|
    v_add_f32_e64 v71, v71, |v71|
    v_add_f32_e64 v72, v72, |v72|
    v_add_f32_e64 v73, v73, |v73|
    v_add_f32_e64 v74, v74, |v74|
    v_add_f32_e64 v75, v75, |v75|
    v_add_f32_e64 v76, v76, |v76|
    v_add_f32_e64 v77, v77, |v77|
    v_add_f32_e64 v78, v78, |v78|
    v_add_f32_e64 v79, v79, |v79|
    v_mul_f32 v64, v64, v222
    v_mul_f32 v65, v65, v222
    v_mul_f32 v66, v66, v222
    v_mul_f32 v67, v67, v222
    v_mul_f32 v68, v68, v222
    v_mul_f32 v69, v69, v222
    v_mul_f32 v70, v70, v222
    v_mul_f32 v71, v71, v222
    v_mul_f32 v72, v72, v222
    v_mul_f32 v73, v73, v222
    v_mul_f32 v74, v74, v222
    v_mul_f32 v75, v75, v222
    v_mul_f32 v76, v76, v222
    v_mul_f32 v77, v77, v222
    v_mul_f32 v78, v78, v222
    v_mul_f32 v79, v79, v222
    v_mul_f32 v64, v64, v64
    v_mul_f32 v65, v65, v65
    v_mul_f32 v66, v66, v66
    v_mul_f32 v67, v67, v67
    v_mul_f32 v68, v68, v68
    v_mul_f32 v69, v69, v69
    v_mul_f32 v70, v70, v70
    v_mul_f32 v71, v71, v71
    v_mul_f32 v72, v72, v72
    v_mul_f32 v73, v73, v73
    v_mul_f32 v74, v74, v74
    v_mul_f32 v75, v75, v75
    v_mul_f32 v76, v76, v76
    v_mul_f32 v77, v77, v77
    v_mul_f32 v78, v78, v78
    v_mul_f32 v79, v79, v79
    v_cvt_pk_bf16_f32 v64, v64, v65
    v_cvt_pk_bf16_f32 v65, v66, v67
    v_cvt_pk_bf16_f32 v66, v68, v69
    v_cvt_pk_bf16_f32 v67, v70, v71
    v_cvt_pk_bf16_f32 v68, v72, v73
    v_cvt_pk_bf16_f32 v69, v74, v75
    v_cvt_pk_bf16_f32 v70, v76, v77
    v_cvt_pk_bf16_f32 v71, v78, v79
    buffer_store_dwordx4 v[64:67], v26, s[24:27], s9 offen sc1
    buffer_store_dwordx4 v[68:71], v26, s[24:27], s9 offen offset:1024 sc1
    s_lshl_b32 s9, s67, 11
    s_add_u32 s9, s9, s64
    v_add_f32_e64 v80, v80, |v80|
    v_add_f32_e64 v81, v81, |v81|
    v_add_f32_e64 v82, v82, |v82|
    v_add_f32_e64 v83, v83, |v83|
    v_add_f32_e64 v84, v84, |v84|
    v_add_f32_e64 v85, v85, |v85|
    v_add_f32_e64 v86, v86, |v86|
    v_add_f32_e64 v87, v87, |v87|
    v_add_f32_e64 v88, v88, |v88|
    v_add_f32_e64 v89, v89, |v89|
    v_add_f32_e64 v90, v90, |v90|
    v_add_f32_e64 v91, v91, |v91|
    v_add_f32_e64 v92, v92, |v92|
    v_add_f32_e64 v93, v93, |v93|
    v_add_f32_e64 v94, v94, |v94|
    v_add_f32_e64 v95, v95, |v95|
    v_mul_f32 v80, v80, v225
    v_mul_f32 v81, v81, v225
    v_mul_f32 v82, v82, v225
    v_mul_f32 v83, v83, v225
    v_mul_f32 v84, v84, v225
    v_mul_f32 v85, v85, v225
    v_mul_f32 v86, v86, v225
    v_mul_f32 v87, v87, v225
    v_mul_f32 v88, v88, v225
    v_mul_f32 v89, v89, v225
    v_mul_f32 v90, v90, v225
    v_mul_f32 v91, v91, v225
    v_mul_f32 v92, v92, v225
    v_mul_f32 v93, v93, v225
    v_mul_f32 v94, v94, v225
    v_mul_f32 v95, v95, v225
    v_mul_f32 v80, v80, v80
    v_mul_f32 v81, v81, v81
    v_mul_f32 v82, v82, v82
    v_mul_f32 v83, v83, v83
    v_mul_f32 v84, v84, v84
    v_mul_f32 v85, v85, v85
    v_mul_f32 v86, v86, v86
    v_mul_f32 v87, v87, v87
    v_mul_f32 v88, v88, v88
    v_mul_f32 v89, v89, v89
    v_mul_f32 v90, v90, v90
    v_mul_f32 v91, v91, v91
    v_mul_f32 v92, v92, v92
    v_mul_f32 v93, v93, v93
    v_mul_f32 v94, v94, v94
    v_mul_f32 v95, v95, v95
    v_cvt_pk_bf16_f32 v80, v80, v81
    v_cvt_pk_bf16_f32 v81, v82, v83
    v_cvt_pk_bf16_f32 v82, v84, v85
    v_cvt_pk_bf16_f32 v83, v86, v87
    v_cvt_pk_bf16_f32 v84, v88, v89
    v_cvt_pk_bf16_f32 v85, v90, v91
    v_cvt_pk_bf16_f32 v86, v92, v93
    v_cvt_pk_bf16_f32 v87, v94, v95
    buffer_store_dwordx4 v[80:83], v26, s[24:27], s9 offen sc1
    buffer_store_dwordx4 v[84:87], v26, s[24:27], s9 offen offset:1024 sc1
    s_waitcnt vmcnt(8)
    ds_read_b64_tr_b16 v[128:129], v14 offset:49152
    ds_read_b64_tr_b16 v[130:131], v14 offset:50176
    ds_read_b64_tr_b16 v[132:133], v15 offset:49152
    ds_read_b64_tr_b16 v[134:135], v15 offset:50176
    ds_read_b64_tr_b16 v[136:137], v16 offset:0
    ds_read_b64_tr_b16 v[138:139], v16 offset:1024
    ds_read_b64_tr_b16 v[140:141], v17 offset:0
    ds_read_b64_tr_b16 v[142:143], v17 offset:1024
    ds_read_b64_tr_b16 v[144:145], v16 offset:16384
    ds_read_b64_tr_b16 v[146:147], v16 offset:17408
    ds_read_b64_tr_b16 v[148:149], v17 offset:16384
    ds_read_b64_tr_b16 v[150:151], v17 offset:17408
    ds_read_b64_tr_b16 v[152:153], v12 offset:16384
    ds_read_b64_tr_b16 v[154:155], v12 offset:17408
    ds_read_b64_tr_b16 v[156:157], v13 offset:16384
    ds_read_b64_tr_b16 v[158:159], v13 offset:17408
    ds_read_b64_tr_b16 v[160:161], v12 offset:32768
    ds_read_b64_tr_b16 v[162:163], v12 offset:33792
    ds_read_b64_tr_b16 v[164:165], v13 offset:32768
    ds_read_b64_tr_b16 v[166:167], v13 offset:33792
    ds_read_b64_tr_b16 v[168:169], v12 offset:49152
    ds_read_b64_tr_b16 v[170:171], v12 offset:50176
    ds_read_b64_tr_b16 v[172:173], v13 offset:49152
    ds_read_b64_tr_b16 v[174:175], v13 offset:50176
    ds_read_b64_tr_b16 v[176:177], v14 offset:0
    ds_read_b64_tr_b16 v[178:179], v14 offset:1024
    ds_read_b64_tr_b16 v[180:181], v15 offset:0
    ds_read_b64_tr_b16 v[182:183], v15 offset:1024
    ds_read_b64_tr_b16 v[184:185], v14 offset:16384
    ds_read_b64_tr_b16 v[186:187], v14 offset:17408
    ds_read_b64_tr_b16 v[188:189], v15 offset:16384
    ds_read_b64_tr_b16 v[190:191], v15 offset:17408
    ds_read_b64_tr_b16 v[192:193], v14 offset:32768
    ds_read_b64_tr_b16 v[194:195], v14 offset:33792
    ds_read_b64_tr_b16 v[196:197], v15 offset:32768
    ds_read_b64_tr_b16 v[198:199], v15 offset:33792
    s_waitcnt vmcnt(0)
    s_lshl_b32 s9, s4, 1
    s_add_u32 s9, s9, s7
    s_lshl_b32 s77, s9, 8
    s_lshl_b32 s10, s79, 2
    s_add_u32 s10, s10, s63
    s_lshl_b32 s10, s10, 2
    s_add_u32 s9, s77, s10
    s_add_u32 s9, s9, 9515008
    v_mov_b32 v31, s75
    s_mov_b64 exec, 1
    buffer_store_dword v31, v19, s[24:27], s9 offen sc1
    s_mov_b64 exec, -1
    s_mov_b32 s81, s61
    s_lshl_b32 s9, s3, 2
    v_mov_b32 v11, s9
    s_waitcnt lgkmcnt(0)
    s_add_u32 m0, s69, 114688
    s_add_u32 s71, s61, 8192
    buffer_load_dwordx4 v18, s[44:47], s61 offen lds
    s_add_u32 m0, s69, 115712
    s_nop 0
    buffer_load_dwordx4 v18, s[44:47], s71 offen lds
    s_add_u32 s61, s61, 16384
    s_cmp_eq_u32 s61, s83
    s_cselect_b32 s61, s60, s61
    s_add_u32 m0, s69, 131072
    s_add_u32 s71, s61, 8192
    buffer_load_dwordx4 v18, s[44:47], s61 offen lds
    s_add_u32 m0, s69, 132096
    s_nop 0
    buffer_load_dwordx4 v18, s[44:47], s71 offen lds
    s_add_u32 s61, s61, 16384
    s_cmp_eq_u32 s61, s83
    s_cselect_b32 s61, s60, s61
    s_add_u32 m0, s69, 147456
    s_add_u32 s71, s61, 8192
    buffer_load_dwordx4 v18, s[44:47], s61 offen lds
    s_add_u32 m0, s69, 148480
    s_nop 0
    buffer_load_dwordx4 v18, s[44:47], s71 offen lds
    s_add_u32 s61, s61, 16384
    s_cmp_eq_u32 s61, s83
    s_cselect_b32 s61, s60, s61
    s_add_u32 m0, s69, 16384
    s_add_u32 s71, s61, 8192
    buffer_load_dwordx4 v18, s[44:47], s61 offen lds
    s_add_u32 m0, s69, 17408
    s_nop 0
    buffer_load_dwordx4 v18, s[44:47], s71 offen lds
    s_add_u32 s61, s61, 16384
    s_cmp_eq_u32 s61, s83
    s_cselect_b32 s61, s60, s61
    s_add_u32 m0, s69, 32768
    s_add_u32 s71, s61, 8192
    buffer_load_dwordx4 v18, s[44:47], s61 offen lds
    s_add_u32 m0, s69, 33792
    s_nop 0
    buffer_load_dwordx4 v18, s[44:47], s71 offen lds
    s_add_u32 s61, s61, 16384
    s_cmp_eq_u32 s61, s83
    s_cselect_b32 s61, s60, s61
    s_add_u32 m0, s69, 49152
    s_add_u32 s71, s68, 0
    buffer_load_dwordx4 v18, s[48:51], s71 offen lds
    s_add_u32 m0, s69, 50176
    s_add_u32 s71, s68, 8192
    buffer_load_dwordx4 v18, s[48:51], s71 offen lds
    s_add_u32 m0, s69, 65536
    s_add_u32 s71, s68, 16384
    buffer_load_dwordx4 v18, s[48:51], s71 offen lds
    s_add_u32 m0, s69, 66560
    s_add_u32 s71, s68, 24576
    buffer_load_dwordx4 v18, s[48:51], s71 offen lds
    s_add_u32 m0, s69, 81920
    s_add_u32 s71, s68, 32768
    buffer_load_dwordx4 v18, s[48:51], s71 offen lds
    s_add_u32 m0, s69, 82944
    s_add_u32 s71, s68, 40960
    buffer_load_dwordx4 v18, s[48:51], s71 offen lds
    s_add_u32 m0, s69, 98304
    s_add_u32 s71, s68, 49152
    buffer_load_dwordx4 v18, s[48:51], s71 offen lds
    s_add_u32 m0, s69, 99328
    s_add_u32 s71, s68, 57344
    buffer_load_dwordx4 v18, s[48:51], s71 offen lds
    s_mov_b32 s71, 0
L_pw:
    ds_read_b32 v10, v11 offset:12304
    s_waitcnt lgkmcnt(0)
    v_readfirstlane_b32 s9, v10
    s_add_u32 s71, s71, 1
    s_cmp_gt_u32 s71, 480000
    s_cbranch_scc1 L_pwx
    s_cmp_eq_u32 s9, s75
    s_cbranch_scc1 L_pwx
    s_sleep 1
    s_branch L_pw
L_pwx:
    s_add_u32 m0, s69, 122880
    s_add_u32 s71, s81, 917504
    buffer_load_dwordx4 v18, s[44:47], s71 offen lds
    s_add_u32 m0, s69, 123904
    s_add_u32 s71, s81, 925696
    buffer_load_dwordx4 v18, s[44:47], s71 offen lds
    s_add_u32 s81, s81, 16384
    s_cmp_eq_u32 s81, s83
    s_cselect_b32 s81, s60, s81
    s_add_u32 m0, s69, 139264
    s_add_u32 s71, s81, 917504
    buffer_load_dwordx4 v18, s[44:47], s71 offen lds
    s_add_u32 m0, s69, 140288
    s_add_u32 s71, s81, 925696
    buffer_load_dwordx4 v18, s[44:47], s71 offen lds
    s_add_u32 s81, s81, 16384
    s_cmp_eq_u32 s81, s83
    s_cselect_b32 s81, s60, s81
    s_add_u32 m0, s69, 155648
    s_add_u32 s71, s81, 917504
    buffer_load_dwordx4 v18, s[44:47], s71 offen lds
    s_add_u32 m0, s69, 156672
    s_add_u32 s71, s81, 925696
    buffer_load_dwordx4 v18, s[44:47], s71 offen lds
    s_add_u32 s81, s81, 16384
    s_cmp_eq_u32 s81, s83
    s_cselect_b32 s81, s60, s81
    s_add_u32 m0, s69, 24576
    s_add_u32 s71, s81, 917504
    buffer_load_dwordx4 v18, s[44:47], s71 offen lds
    s_add_u32 m0, s69, 25600
    s_add_u32 s71, s81, 925696
    buffer_load_dwordx4 v18, s[44:47], s71 offen lds
    s_add_u32 s81, s81, 16384
    s_cmp_eq_u32 s81, s83
    s_cselect_b32 s81, s60, s81
    s_add_u32 m0, s69, 40960
    s_add_u32 s71, s81, 917504
    buffer_load_dwordx4 v18, s[44:47], s71 offen lds
    s_add_u32 m0, s69, 41984
    s_add_u32 s71, s81, 925696
    buffer_load_dwordx4 v18, s[44:47], s71 offen lds
    s_add_u32 s81, s81, 16384
    s_cmp_eq_u32 s81, s83
    s_cselect_b32 s81, s60, s81
    s_add_u32 m0, s69, 57344
    s_add_u32 s71, s68, 262144
    buffer_load_dwordx4 v18, s[48:51], s71 offen lds
    s_add_u32 m0, s69, 58368
    s_add_u32 s71, s68, 270336
    buffer_load_dwordx4 v18, s[48:51], s71 offen lds
    s_add_u32 m0, s69, 73728
    s_add_u32 s71, s68, 278528
    buffer_load_dwordx4 v18, s[48:51], s71 offen lds
    s_add_u32 m0, s69, 74752
    s_add_u32 s71, s68, 286720
    buffer_load_dwordx4 v18, s[48:51], s71 offen lds
    s_add_u32 m0, s69, 90112
    s_add_u32 s71, s68, 294912
    buffer_load_dwordx4 v18, s[48:51], s71 offen lds
    s_add_u32 m0, s69, 91136
    s_add_u32 s71, s68, 303104
    buffer_load_dwordx4 v18, s[48:51], s71 offen lds
    s_add_u32 m0, s69, 106496
    s_add_u32 s71, s68, 311296
    buffer_load_dwordx4 v18, s[48:51], s71 offen lds
    s_add_u32 m0, s69, 107520
    s_add_u32 s71, s68, 319488
    buffer_load_dwordx4 v18, s[48:51], s71 offen lds
    s_waitcnt vmcnt(0)
    v_mov_b32 v10, s75
    ds_write_b32 v11, v10 offset:12320
    s_branch L_tailB
L_Bq:
    s_add_u32 s9, s65, 112
    s_lshl_b32 s9, s9, 10
    s_add_u32 s10, s9, s64
    s_add_u32 s9, s9, s74
    v_mov_b32 v4, -1
    v_mov_b32 v5, -1
    v_mov_b32 v6, -1
    v_mov_b32 v7, -1
    buffer_store_dwordx4 v[4:7], v26, s[24:27], s9 offen offset:0 sc1
    buffer_store_dwordx4 v[4:7], v26, s[24:27], s9 offen offset:1024 sc1
    buffer_store_dwordx4 v[4:7], v26, s[24:27], s10 offen offset:0 sc1
    buffer_store_dwordx4 v[4:7], v26, s[24:27], s10 offen offset:1024 sc1
    s_lshl_b32 s9, s67, 11
    s_add_u32 s9, s9, s74
    v_add_f32_e64 v64, v64, |v64|
    v_add_f32_e64 v65, v65, |v65|
    v_add_f32_e64 v66, v66, |v66|
    v_add_f32_e64 v67, v67, |v67|
    v_add_f32_e64 v68, v68, |v68|
    v_add_f32_e64 v69, v69, |v69|
    v_add_f32_e64 v70, v70, |v70|
    v_add_f32_e64 v71, v71, |v71|
    v_add_f32_e64 v72, v72, |v72|
    v_add_f32_e64 v73, v73, |v73|
    v_add_f32_e64 v74, v74, |v74|
    v_add_f32_e64 v75, v75, |v75|
    v_add_f32_e64 v76, v76, |v76|
    v_add_f32_e64 v77, v77, |v77|
    v_add_f32_e64 v78, v78, |v78|
    v_add_f32_e64 v79, v79, |v79|
    v_mul_f32 v64, v64, v222
    v_mul_f32 v65, v65, v222
    v_mul_f32 v66, v66, v222
    v_mul_f32 v67, v67, v222
    v_mul_f32 v68, v68, v222
    v_mul_f32 v69, v69, v222
    v_mul_f32 v70, v70, v222
    v_mul_f32 v71, v71, v222
    v_mul_f32 v72, v72, v222
    v_mul_f32 v73, v73, v222
    v_mul_f32 v74, v74, v222
    v_mul_f32 v75, v75, v222
    v_mul_f32 v76, v76, v222
    v_mul_f32 v77, v77, v222
    v_mul_f32 v78, v78, v222
    v_mul_f32 v79, v79, v222
    v_mul_f32 v64, v64, v64
    v_mul_f32 v65, v65, v65
    v_mul_f32 v66, v66, v66
    v_mul_f32 v67, v67, v67
    v_mul_f32 v68, v68, v68
    v_mul_f32 v69, v69, v69
    v_mul_f32 v70, v70, v70
    v_mul_f32 v71, v71, v71
    v_mul_f32 v72, v72, v72
    v_mul_f32 v73, v73, v73
    v_mul_f32 v74, v74, v74
    v_mul_f32 v75, v75, v75
    v_mul_f32 v76, v76, v76
    v_mul_f32 v77, v77, v77
    v_mul_f32 v78, v78, v78
    v_mul_f32 v79, v79, v79
    v_cvt_pk_bf16_f32 v64, v64, v65
    v_cvt_pk_bf16_f32 v65, v66, v67
    v_cvt_pk_bf16_f32 v66, v68, v69
    v_cvt_pk_bf16_f32 v67, v70, v71
    v_cvt_pk_bf16_f32 v68, v72, v73
    v_cvt_pk_bf16_f32 v69, v74, v75
    v_cvt_pk_bf16_f32 v70, v76, v77
    v_cvt_pk_bf16_f32 v71, v78, v79
    buffer_store_dwordx4 v[64:67], v26, s[24:27], s9 offen sc1
    buffer_store_dwordx4 v[68:71], v26, s[24:27], s9 offen offset:1024 sc1
    v_lshlrev_b32 v8, 3, v1
    s_lshl_b32 s66, s6, 9
    s_add_u32 s66, s66, 9510912
    s_mul_i32 s11, s78, 4352
    v_cvt_pk_bf16_f32 v32, v32, v33
    v_cvt_pk_bf16_f32 v33, v34, v35
    v_cvt_pk_bf16_f32 v34, v36, v37
    v_cvt_pk_bf16_f32 v35, v38, v39
    v_cvt_pk_bf16_f32 v36, v40, v41
    v_cvt_pk_bf16_f32 v37, v42, v43
    v_cvt_pk_bf16_f32 v38, v44, v45
    v_cvt_pk_bf16_f32 v39, v46, v47
    v_mfma_f32_32x32x16_bf16 v[96:111], v[200:203], v[32:35], 0
    s_nop 11
    v_max3_f32 v2, v96, v97, v98
    v_max3_f32 v3, -v96, -v97, -v98
    v_max3_f32 v2, v2, v99, v100
    v_max3_f32 v3, v3, -v99, -v100
    v_max3_f32 v2, v2, v101, v102
    v_max3_f32 v3, v3, -v101, -v102
    v_max_f32 v2, v2, v103
    v_max_f32_e64 v3, v3, -v103
    s_nop 1
    v_permlane32_swap_b32 v2, v3
    v_max_f32 v2, v2, v3
    v_mul_f32_e64 v2, -v2, v221
    v_mov_b32 v3, v2
    s_nop 1
    v_permlane32_swap_b32 v2, v3
    v_fma_f32 v112, -v96, v221, v3
    v_fma_f32 v96, v96, v221, v2
    v_fma_f32 v113, -v97, v221, v3
    v_fma_f32 v97, v97, v221, v2
    v_fma_f32 v114, -v98, v221, v3
    v_fma_f32 v98, v98, v221, v2
    v_fma_f32 v115, -v99, v221, v3
    v_fma_f32 v99, v99, v221, v2
    v_fma_f32 v116, -v100, v221, v3
    v_fma_f32 v100, v100, v221, v2
    v_fma_f32 v117, -v101, v221, v3
    v_fma_f32 v101, v101, v221, v2
    v_fma_f32 v118, -v102, v221, v3
    v_fma_f32 v102, v102, v221, v2
    v_fma_f32 v119, -v103, v221, v3
    v_fma_f32 v103, v103, v221, v2
    v_exp_f32 v112, v112
    v_exp_f32 v96, v96
    v_exp_f32 v113, v113
    v_exp_f32 v97, v97
    v_exp_f32 v114, v114
    v_exp_f32 v98, v98
    v_exp_f32 v115, v115
    v_exp_f32 v99, v99
    v_exp_f32 v116, v116
    v_exp_f32 v100, v100
    v_exp_f32 v117, v117
    v_exp_f32 v101, v101
    v_exp_f32 v118, v118
    v_exp_f32 v102, v102
    v_exp_f32 v119, v119
    v_exp_f32 v103, v103
    v_add_f32 v2, v96, v97
    v_add_f32 v3, v112, v113
    v_add_f32 v2, v2, v98
    v_add_f32 v3, v3, v114
    v_add_f32 v2, v2, v99
    v_add_f32 v3, v3, v115
    v_add_f32 v2, v2, v100
    v_add_f32 v3, v3, v116
    v_add_f32 v2, v2, v101
    v_add_f32 v3, v3, v117
    v_add_f32 v2, v2, v102
    v_add_f32 v3, v3, v118
    v_add_f32 v2, v2, v103
    v_add_f32 v3, v3, v119
    s_nop 1
    v_permlane32_swap_b32 v2, v3
    v_add_f32 v2, v2, v3
    v_rcp_f32 v2, v2
    s_nop 0
    v_mov_b32 v3, v2
    s_nop 1
    v_permlane32_swap_b32 v2, v3
    v_mul_f32 v96, v96, v2
    v_mul_f32 v112, v112, v3
    v_mul_f32 v97, v97, v2
    v_mul_f32 v113, v113, v3
    v_mul_f32 v98, v98, v2
    v_mul_f32 v114, v114, v3
    v_mul_f32 v99, v99, v2
    v_mul_f32 v115, v115, v3
    v_mul_f32 v100, v100, v2
    v_mul_f32 v116, v116, v3
    v_mul_f32 v101, v101, v2
    v_mul_f32 v117, v117, v3
    v_mul_f32 v102, v102, v2
    v_mul_f32 v118, v118, v3
    v_mul_f32 v103, v103, v2
    v_mul_f32 v119, v119, v3
    v_cvt_pk_bf16_f32 v80, v96, v97
    v_cvt_pk_bf16_f32 v84, v112, v113
    v_cvt_pk_bf16_f32 v81, v98, v99
    v_cvt_pk_bf16_f32 v85, v114, v115
    v_cvt_pk_bf16_f32 v82, v100, v101
    v_cvt_pk_bf16_f32 v86, v116, v117
    v_cvt_pk_bf16_f32 v83, v102, v103
    v_cvt_pk_bf16_f32 v87, v118, v119
    v_mfma_f32_32x32x16_bf16 v[96:111], v[204:207], v[36:39], 0
    s_waitcnt vmcnt(0)
    s_lshl_b32 s9, s4, 1
    s_add_u32 s9, s9, s7
    s_lshl_b32 s77, s9, 8
    s_lshl_b32 s10, s79, 2
    s_add_u32 s10, s10, s63
    s_lshl_b32 s10, s10, 2
    s_add_u32 s9, s77, s10
    s_add_u32 s9, s9, 9515008
    v_mov_b32 v31, s75
    s_mov_b64 exec, 1
    buffer_store_dword v31, v19, s[24:27], s9 offen sc1
    s_mov_b64 exec, -1
    ds_read_b64_tr_b16 v[128:129], v14 offset:49152
    ds_read_b64_tr_b16 v[130:131], v14 offset:50176
    ds_read_b64_tr_b16 v[132:133], v15 offset:49152
    ds_read_b64_tr_b16 v[134:135], v15 offset:50176
    ds_read_b64_tr_b16 v[136:137], v16 offset:0
    ds_read_b64_tr_b16 v[138:139], v16 offset:1024
    ds_read_b64_tr_b16 v[140:141], v17 offset:0
    ds_read_b64_tr_b16 v[142:143], v17 offset:1024
    ds_read_b64_tr_b16 v[144:145], v16 offset:16384
    ds_read_b64_tr_b16 v[146:147], v16 offset:17408
    ds_read_b64_tr_b16 v[148:149], v17 offset:16384
    ds_read_b64_tr_b16 v[150:151], v17 offset:17408
    ds_read_b64_tr_b16 v[152:153], v12 offset:16384
    ds_read_b64_tr_b16 v[154:155], v12 offset:17408
    ds_read_b64_tr_b16 v[156:157], v13 offset:16384
    ds_read_b64_tr_b16 v[158:159], v13 offset:17408
    ds_read_b64_tr_b16 v[160:161], v12 offset:32768
    ds_read_b64_tr_b16 v[162:163], v12 offset:33792
    ds_read_b64_tr_b16 v[164:165], v13 offset:32768
    ds_read_b64_tr_b16 v[166:167], v13 offset:33792
    ds_read_b64_tr_b16 v[168:169], v12 offset:49152
    ds_read_b64_tr_b16 v[170:171], v12 offset:50176
    ds_read_b64_tr_b16 v[172:173], v13 offset:49152
    ds_read_b64_tr_b16 v[174:175], v13 offset:50176
    ds_read_b64_tr_b16 v[176:177], v14 offset:0
    ds_read_b64_tr_b16 v[178:179], v14 offset:1024
    ds_read_b64_tr_b16 v[180:181], v15 offset:0
    ds_read_b64_tr_b16 v[182:183], v15 offset:1024
    ds_read_b64_tr_b16 v[184:185], v14 offset:16384
    ds_read_b64_tr_b16 v[186:187], v14 offset:17408
    ds_read_b64_tr_b16 v[188:189], v15 offset:16384
    ds_read_b64_tr_b16 v[190:191], v15 offset:17408
    ds_read_b64_tr_b16 v[192:193], v14 offset:32768
    ds_read_b64_tr_b16 v[194:195], v14 offset:33792
    ds_read_b64_tr_b16 v[196:197], v15 offset:32768
    ds_read_b64_tr_b16 v[198:199], v15 offset:33792
    v_max3_f32 v2, v96, v97, v98
    v_max3_f32 v3, -v96, -v97, -v98
    v_max3_f32 v2, v2, v99, v100
    v_max3_f32 v3, v3, -v99, -v100
    v_max3_f32 v2, v2, v101, v102
    v_max3_f32 v3, v3, -v101, -v102
    v_max_f32 v2, v2, v103
    v_max_f32_e64 v3, v3, -v103
    s_nop 1
    v_permlane32_swap_b32 v2, v3
    v_max_f32 v2, v2, v3
    v_mul_f32_e64 v2, -v2, v221
    v_mov_b32 v3, v2
    s_nop 1
    v_permlane32_swap_b32 v2, v3
    v_fma_f32 v112, -v96, v221, v3
    v_fma_f32 v96, v96, v221, v2
    v_fma_f32 v113, -v97, v221, v3
    v_fma_f32 v97, v97, v221, v2
    v_fma_f32 v114, -v98, v221, v3
    v_fma_f32 v98, v98, v221, v2
    v_fma_f32 v115, -v99, v221, v3
    v_fma_f32 v99, v99, v221, v2
    v_fma_f32 v116, -v100, v221, v3
    v_fma_f32 v100, v100, v221, v2
    v_fma_f32 v117, -v101, v221, v3
    v_fma_f32 v101, v101, v221, v2
    v_fma_f32 v118, -v102, v221, v3
    v_fma_f32 v102, v102, v221, v2
    v_fma_f32 v119, -v103, v221, v3
    v_fma_f32 v103, v103, v221, v2
    v_exp_f32 v112, v112
    v_exp_f32 v96, v96
    v_exp_f32 v113, v113
    v_exp_f32 v97, v97
    v_exp_f32 v114, v114
    v_exp_f32 v98, v98
    v_exp_f32 v115, v115
    v_exp_f32 v99, v99
    v_exp_f32 v116, v116
    v_exp_f32 v100, v100
    v_exp_f32 v117, v117
    v_exp_f32 v101, v101
    v_exp_f32 v118, v118
    v_exp_f32 v102, v102
    v_exp_f32 v119, v119
    v_exp_f32 v103, v103
    v_add_f32 v2, v96, v97
    v_add_f32 v3, v112, v113
    v_add_f32 v2, v2, v98
    v_add_f32 v3, v3, v114
    v_add_f32 v2, v2, v99
    v_add_f32 v3, v3, v115
    v_add_f32 v2, v2, v100
    v_add_f32 v3, v3, v116
    v_add_f32 v2, v2, v101
    v_add_f32 v3, v3, v117
    v_add_f32 v2, v2, v102
    v_add_f32 v3, v3, v118
    v_add_f32 v2, v2, v103
    v_add_f32 v3, v3, v119
    s_nop 1
    v_permlane32_swap_b32 v2, v3
    v_add_f32 v2, v2, v3
    v_rcp_f32 v2, v2
    s_nop 0
    v_mov_b32 v3, v2
    s_nop 1
    v_permlane32_swap_b32 v2, v3
    v_mul_f32 v96, v96, v2
    v_mul_f32 v112, v112, v3
    v_mul_f32 v97, v97, v2
    v_mul_f32 v113, v113, v3
    v_mul_f32 v98, v98, v2
    v_mul_f32 v114, v114, v3
    v_mul_f32 v99, v99, v2
    v_mul_f32 v115, v115, v3
    v_mul_f32 v100, v100, v2
    v_mul_f32 v116, v116, v3
    v_mul_f32 v101, v101, v2
    v_mul_f32 v117, v117, v3
    v_mul_f32 v102, v102, v2
    v_mul_f32 v118, v118, v3
    v_mul_f32 v103, v103, v2
    v_mul_f32 v119, v119, v3
    v_cvt_pk_bf16_f32 v88, v96, v97
    v_cvt_pk_bf16_f32 v92, v112, v113
    v_cvt_pk_bf16_f32 v89, v98, v99
    v_cvt_pk_bf16_f32 v93, v114, v115
    v_cvt_pk_bf16_f32 v90, v100, v101
    v_cvt_pk_bf16_f32 v94, v116, v117
    v_cvt_pk_bf16_f32 v91, v102, v103
    v_cvt_pk_bf16_f32 v95, v118, v119
    v_cvt_pk_bf16_f32 v48, v48, v49
    v_cvt_pk_bf16_f32 v49, v50, v51
    v_cvt_pk_bf16_f32 v50, v52, v53
    v_cvt_pk_bf16_f32 v51, v54, v55
    v_cvt_pk_bf16_f32 v52, v56, v57
    v_cvt_pk_bf16_f32 v53, v58, v59
    v_cvt_pk_bf16_f32 v54, v60, v61
    v_cvt_pk_bf16_f32 v55, v62, v63
    v_mfma_f32_32x32x16_bf16 v[96:111], v[200:203], v[48:51], 0
    s_waitcnt lgkmcnt(0)
    s_lshl_b32 s9, s3, 2
    v_mov_b32 v9, s9
    v_mov_b32 v10, s75
    ds_write_b32 v9, v10 offset:12288
    s_nop 6
    v_max3_f32 v2, v96, v97, v98
    v_max3_f32 v3, -v96, -v97, -v98
    v_max3_f32 v2, v2, v99, v100
    v_max3_f32 v3, v3, -v99, -v100
    v_max3_f32 v2, v2, v101, v102
    v_max3_f32 v3, v3, -v101, -v102
    v_max_f32 v2, v2, v103
    v_max_f32_e64 v3, v3, -v103
    s_nop 1
    v_permlane32_swap_b32 v2, v3
    v_max_f32 v2, v2, v3
    v_mul_f32_e64 v2, -v2, v224
    v_mov_b32 v3, v2
    s_nop 1
    v_permlane32_swap_b32 v2, v3
    v_fma_f32 v112, -v96, v224, v3
    v_fma_f32 v96, v96, v224, v2
    v_fma_f32 v113, -v97, v224, v3
    v_fma_f32 v97, v97, v224, v2
    v_fma_f32 v114, -v98, v224, v3
    v_fma_f32 v98, v98, v224, v2
    v_fma_f32 v115, -v99, v224, v3
    v_fma_f32 v99, v99, v224, v2
    v_fma_f32 v116, -v100, v224, v3
    v_fma_f32 v100, v100, v224, v2
    v_fma_f32 v117, -v101, v224, v3
    v_fma_f32 v101, v101, v224, v2
    v_fma_f32 v118, -v102, v224, v3
    v_fma_f32 v102, v102, v224, v2
    v_fma_f32 v119, -v103, v224, v3
    v_fma_f32 v103, v103, v224, v2
    v_exp_f32 v112, v112
    v_exp_f32 v96, v96
    v_exp_f32 v113, v113
    v_exp_f32 v97, v97
    v_exp_f32 v114, v114
    v_exp_f32 v98, v98
    v_exp_f32 v115, v115
    v_exp_f32 v99, v99
    v_exp_f32 v116, v116
    v_exp_f32 v100, v100
    v_exp_f32 v117, v117
    v_exp_f32 v101, v101
    v_exp_f32 v118, v118
    v_exp_f32 v102, v102
    v_exp_f32 v119, v119
    v_exp_f32 v103, v103
    v_add_f32 v2, v96, v97
    v_add_f32 v3, v112, v113
    v_add_f32 v2, v2, v98
    v_add_f32 v3, v3, v114
    v_add_f32 v2, v2, v99
    v_add_f32 v3, v3, v115
    v_add_f32 v2, v2, v100
    v_add_f32 v3, v3, v116
    v_add_f32 v2, v2, v101
    v_add_f32 v3, v3, v117
    v_add_f32 v2, v2, v102
    v_add_f32 v3, v3, v118
    v_add_f32 v2, v2, v103
    v_add_f32 v3, v3, v119
    s_nop 1
    v_permlane32_swap_b32 v2, v3
    v_add_f32 v2, v2, v3
    v_rcp_f32 v2, v2
    s_nop 0
    v_mov_b32 v3, v2
    s_nop 1
    v_permlane32_swap_b32 v2, v3
    v_mul_f32 v96, v96, v2
    v_mul_f32 v112, v112, v3
    v_mul_f32 v97, v97, v2
    v_mul_f32 v113, v113, v3
    v_mul_f32 v98, v98, v2
    v_mul_f32 v114, v114, v3
    v_mul_f32 v99, v99, v2
    v_mul_f32 v115, v115, v3
    v_mul_f32 v100, v100, v2
    v_mul_f32 v116, v116, v3
    v_mul_f32 v101, v101, v2
    v_mul_f32 v117, v117, v3
    v_mul_f32 v102, v102, v2
    v_mul_f32 v118, v118, v3
    v_mul_f32 v103, v103, v2
    v_mul_f32 v119, v119, v3
    v_cvt_pk_bf16_f32 v232, v96, v97
    v_cvt_pk_bf16_f32 v236, v112, v113
    v_cvt_pk_bf16_f32 v233, v98, v99
    v_cvt_pk_bf16_f32 v237, v114, v115
    v_cvt_pk_bf16_f32 v234, v100, v101
    v_cvt_pk_bf16_f32 v238, v116, v117
    v_cvt_pk_bf16_f32 v235, v102, v103
    v_cvt_pk_bf16_f32 v239, v118, v119
    v_mfma_f32_32x32x16_bf16 v[96:111], v[204:207], v[52:55], 0
    s_nop 11
    v_max3_f32 v2, v96, v97, v98
    v_max3_f32 v3, -v96, -v97, -v98
    v_max3_f32 v2, v2, v99, v100
    v_max3_f32 v3, v3, -v99, -v100
    v_max3_f32 v2, v2, v101, v102
    v_max3_f32 v3, v3, -v101, -v102
    v_max_f32 v2, v2, v103
    v_max_f32_e64 v3, v3, -v103
    s_nop 1
    v_permlane32_swap_b32 v2, v3
    v_max_f32 v2, v2, v3
    v_mul_f32_e64 v2, -v2, v224
    v_mov_b32 v3, v2
    s_nop 1
    v_permlane32_swap_b32 v2, v3
    v_fma_f32 v112, -v96, v224, v3
    v_fma_f32 v96, v96, v224, v2
    v_fma_f32 v113, -v97, v224, v3
    v_fma_f32 v97, v97, v224, v2
    v_fma_f32 v114, -v98, v224, v3
    v_fma_f32 v98, v98, v224, v2
    v_fma_f32 v115, -v99, v224, v3
    v_fma_f32 v99, v99, v224, v2
    v_fma_f32 v116, -v100, v224, v3
    v_fma_f32 v100, v100, v224, v2
    v_fma_f32 v117, -v101, v224, v3
    v_fma_f32 v101, v101, v224, v2
    v_fma_f32 v118, -v102, v224, v3
    v_fma_f32 v102, v102, v224, v2
    v_fma_f32 v119, -v103, v224, v3
    v_fma_f32 v103, v103, v224, v2
    v_exp_f32 v112, v112
    v_exp_f32 v96, v96
    v_exp_f32 v113, v113
    v_exp_f32 v97, v97
    v_exp_f32 v114, v114
    v_exp_f32 v98, v98
    v_exp_f32 v115, v115
    v_exp_f32 v99, v99
    v_exp_f32 v116, v116
    v_exp_f32 v100, v100
    v_exp_f32 v117, v117
    v_exp_f32 v101, v101
    v_exp_f32 v118, v118
    v_exp_f32 v102, v102
    v_exp_f32 v119, v119
    v_exp_f32 v103, v103
    v_add_f32 v2, v96, v97
    v_add_f32 v3, v112, v113
    v_add_f32 v2, v2, v98
    v_add_f32 v3, v3, v114
    v_add_f32 v2, v2, v99
    v_add_f32 v3, v3, v115
    v_add_f32 v2, v2, v100
    v_add_f32 v3, v3, v116
    v_add_f32 v2, v2, v101
    v_add_f32 v3, v3, v117
    v_add_f32 v2, v2, v102
    v_add_f32 v3, v3, v118
    v_add_f32 v2, v2, v103
    v_add_f32 v3, v3, v119
    s_nop 1
    v_permlane32_swap_b32 v2, v3
    v_add_f32 v2, v2, v3
    v_rcp_f32 v2, v2
    s_nop 0
    v_mov_b32 v3, v2
    s_nop 1
    v_permlane32_swap_b32 v2, v3
    v_mul_f32 v96, v96, v2
    v_mul_f32 v112, v112, v3
    v_mul_f32 v97, v97, v2
    v_mul_f32 v113, v113, v3
    v_mul_f32 v98, v98, v2
    v_mul_f32 v114, v114, v3
    v_mul_f32 v99, v99, v2
    v_mul_f32 v115, v115, v3
    v_mul_f32 v100, v100, v2
    v_mul_f32 v116, v116, v3
    v_mul_f32 v101, v101, v2
    v_mul_f32 v117, v117, v3
    v_mul_f32 v102, v102, v2
    v_mul_f32 v118, v118, v3
    v_mul_f32 v103, v103, v2
    v_mul_f32 v119, v119, v3
    v_cvt_pk_bf16_f32 v240, v96, v97
    v_cvt_pk_bf16_f32 v244, v112, v113
    v_cvt_pk_bf16_f32 v241, v98, v99
    v_cvt_pk_bf16_f32 v245, v114, v115
    v_cvt_pk_bf16_f32 v242, v100, v101
    v_cvt_pk_bf16_f32 v246, v116, v117
    v_cvt_pk_bf16_f32 v243, v102, v103
    v_cvt_pk_bf16_f32 v247, v118, v119
    v_min_u32 v9, 16, v29
    v_mul_u32_u24 v10, 17, v30
    v_add_u32 v9, v9, v10
    v_lshlrev_b32 v9, 2, v9
    v_add_u32 v9, s11, v9
    s_cmp_eq_u32 s3, 4
    s_cbranch_scc0 L_nopk
    s_mov_b32 s71, 0
L_pk:
    buffer_load_dwordx2 v[10:11], v8, s[24:27], s66 offen sc1
    s_waitcnt vmcnt(0)
    v_cmp_ne_u32 vcc, s75, v10
    v_cmp_ne_u32 s[80:81], s75, v11
    s_or_b64 vcc, vcc, s[80:81]
    s_cmp_eq_u64 vcc, 0
    s_cbranch_scc1 L_pk2
    s_add_u32 s71, s71, 1
    s_cmp_gt_u32 s71, 60000
    s_cbranch_scc1 L_pk2
    s_sleep 8
    s_branch L_pk
L_pk2:
    s_mov_b32 m0, 0
    s_add_u32 s10, s72, 0
    buffer_load_dwordx4 v26, s[24:27], s10 offen sc1 lds
    s_mov_b32 m0, 1024
    s_add_u32 s10, s72, 1024
    buffer_load_dwordx4 v26, s[24:27], s10 offen sc1 lds
    s_mov_b32 m0, 2048
    s_add_u32 s10, s72, 2048
    buffer_load_dwordx4 v26, s[24:27], s10 offen sc1 lds
    s_mov_b32 m0, 3072
    s_add_u32 s10, s72, 3072
    buffer_load_dwordx4 v26, s[24:27], s10 offen sc1 lds
    s_mov_b32 m0, 4096
    s_add_u32 s10, s72, 4096
    buffer_load_dwordx4 v26, s[24:27], s10 offen sc1 lds
    s_mov_b32 m0, 5120
    s_add_u32 s10, s72, 5120
    buffer_load_dwordx4 v26, s[24:27], s10 offen sc1 lds
    s_mov_b32 m0, 6144
    s_add_u32 s10, s72, 6144
    buffer_load_dwordx4 v26, s[24:27], s10 offen sc1 lds
    s_mov_b32 m0, 7168
    s_add_u32 s10, s72, 7168
    buffer_load_dwordx4 v26, s[24:27], s10 offen sc1 lds
    s_mov_b32 m0, 8192
    s_add_u32 s10, s72, 8192
    buffer_load_dwordx4 v26, s[24:27], s10 offen sc1 lds
    s_waitcnt vmcnt(0)
    v_mov_b32 v10, s75
    ds_write_b32 v19, v10 offset:12288
L_nopk:
    s_mov_b32 s71, 0
L_lf1:
    ds_read_b32 v10, v19 offset:12288
    s_waitcnt lgkmcnt(0)
    v_readfirstlane_b32 s9, v10
    s_add_u32 s71, s71, 1
    s_cmp_gt_u32 s71, 480000
    s_cbranch_scc1 L_lf2
    s_cmp_eq_u32 s9, s75
    s_cbranch_scc1 L_lf2
    s_sleep 1
    s_branch L_lf1
L_lf2:
    ds_read_b32 v32, v9 offset:0
    ds_read_b32 v33, v9 offset:136
    ds_read_b32 v34, v9 offset:272
    ds_read_b32 v35, v9 offset:408
    ds_read_b32 v36, v9 offset:544
    ds_read_b32 v37, v9 offset:680
    ds_read_b32 v38, v9 offset:816
    ds_read_b32 v39, v9 offset:952
    ds_read_b32 v40, v9 offset:1088
    ds_read_b32 v41, v9 offset:1224
    ds_read_b32 v42, v9 offset:1360
    ds_read_b32 v43, v9 offset:1496
    ds_read_b32 v44, v9 offset:1632
    ds_read_b32 v45, v9 offset:1768
    ds_read_b32 v46, v9 offset:1904
    ds_read_b32 v47, v9 offset:2040
    ds_read_b32 v48, v9 offset:2176
    ds_read_b32 v49, v9 offset:2312
    ds_read_b32 v50, v9 offset:2448
    ds_read_b32 v51, v9 offset:2584
    ds_read_b32 v52, v9 offset:2720
    ds_read_b32 v53, v9 offset:2856
    ds_read_b32 v54, v9 offset:2992
    ds_read_b32 v55, v9 offset:3128
    ds_read_b32 v56, v9 offset:3264
    ds_read_b32 v57, v9 offset:3400
    ds_read_b32 v58, v9 offset:3536
    ds_read_b32 v59, v9 offset:3672
    ds_read_b32 v60, v9 offset:3808
    ds_read_b32 v61, v9 offset:3944
    ds_read_b32 v62, v9 offset:4080
    ds_read_b32 v63, v9 offset:4216
    s_add_u32 s9, s65, 112
    s_lshl_b32 s9, s9, 10
    s_add_u32 s10, s9, s64
    s_add_u32 s9, s9, s74
    s_waitcnt lgkmcnt(15)
    v_cvt_pk_bf16_f32 v32, v32, v33
    v_cvt_pk_bf16_f32 v33, v34, v35
    v_cvt_pk_bf16_f32 v34, v36, v37
    v_cvt_pk_bf16_f32 v35, v38, v39
    v_cvt_pk_bf16_f32 v36, v40, v41
    v_cvt_pk_bf16_f32 v37, v42, v43
    v_cvt_pk_bf16_f32 v38, v44, v45
    v_cvt_pk_bf16_f32 v39, v46, v47
    v_mfma_f32_32x32x16_bf16 v[96:111], v[32:35], v[80:83], 0
    s_nop 0
    v_mfma_f32_32x32x16_bf16 v[96:111], v[36:39], v[84:87], v[96:111]
    v_mfma_f32_32x32x16_bf16 v[112:127], v[32:35], v[232:235], 0
    v_mfma_f32_32x32x16_bf16 v[112:127], v[36:39], v[236:239], v[112:127]
    s_nop 9
    v_add_f32 v8, 0x358637bd, v104
    v_rcp_f32 v8, v8
    s_nop 0
    v_mul_f32 v96, v96, v8
    v_mul_f32 v97, v97, v8
    v_mul_f32 v98, v98, v8
    v_mul_f32 v99, v99, v8
    v_mul_f32 v100, v100, v8
    v_mul_f32 v101, v101, v8
    v_mul_f32 v102, v102, v8
    v_mul_f32 v103, v103, v8
    v_cvt_pk_bf16_f32 v40, v96, v97
    v_cvt_pk_bf16_f32 v41, v98, v99
    v_cvt_pk_bf16_f32 v42, v100, v101
    v_cvt_pk_bf16_f32 v43, v102, v103
    buffer_store_dwordx4 v[40:43], v26, s[24:27], s9 offen offset:0 sc1
    v_add_f32 v8, 0x358637bd, v120
    v_rcp_f32 v8, v8
    s_nop 0
    v_mul_f32 v112, v112, v8
    v_mul_f32 v113, v113, v8
    v_mul_f32 v114, v114, v8
    v_mul_f32 v115, v115, v8
    v_mul_f32 v116, v116, v8
    v_mul_f32 v117, v117, v8
    v_mul_f32 v118, v118, v8
    v_mul_f32 v119, v119, v8
    v_cvt_pk_bf16_f32 v44, v112, v113
    v_cvt_pk_bf16_f32 v45, v114, v115
    v_cvt_pk_bf16_f32 v46, v116, v117
    v_cvt_pk_bf16_f32 v47, v118, v119
    buffer_store_dwordx4 v[44:47], v26, s[24:27], s10 offen offset:0 sc1
    s_waitcnt lgkmcnt(0)
    v_cvt_pk_bf16_f32 v48, v48, v49
    v_cvt_pk_bf16_f32 v49, v50, v51
    v_cvt_pk_bf16_f32 v50, v52, v53
    v_cvt_pk_bf16_f32 v51, v54, v55
    v_cvt_pk_bf16_f32 v52, v56, v57
    v_cvt_pk_bf16_f32 v53, v58, v59
    v_cvt_pk_bf16_f32 v54, v60, v61
    v_cvt_pk_bf16_f32 v55, v62, v63
    v_mfma_f32_32x32x16_bf16 v[96:111], v[48:51], v[88:91], 0
    s_nop 0
    v_mfma_f32_32x32x16_bf16 v[96:111], v[52:55], v[92:95], v[96:111]
    v_mfma_f32_32x32x16_bf16 v[112:127], v[48:51], v[240:243], 0
    v_mfma_f32_32x32x16_bf16 v[112:127], v[52:55], v[244:247], v[112:127]
    s_nop 9
    v_add_f32 v8, 0x358637bd, v104
    v_rcp_f32 v8, v8
    s_nop 0
    v_mul_f32 v96, v96, v8
    v_mul_f32 v97, v97, v8
    v_mul_f32 v98, v98, v8
    v_mul_f32 v99, v99, v8
    v_mul_f32 v100, v100, v8
    v_mul_f32 v101, v101, v8
    v_mul_f32 v102, v102, v8
    v_mul_f32 v103, v103, v8
    v_cvt_pk_bf16_f32 v56, v96, v97
    v_cvt_pk_bf16_f32 v57, v98, v99
    v_cvt_pk_bf16_f32 v58, v100, v101
    v_cvt_pk_bf16_f32 v59, v102, v103
    buffer_store_dwordx4 v[56:59], v26, s[24:27], s9 offen offset:1024 sc1
    v_add_f32 v8, 0x358637bd, v120
    v_rcp_f32 v8, v8
    s_nop 0
    v_mul_f32 v112, v112, v8
    v_mul_f32 v113, v113, v8
    v_mul_f32 v114, v114, v8
    v_mul_f32 v115, v115, v8
    v_mul_f32 v116, v116, v8
    v_mul_f32 v117, v117, v8
    v_mul_f32 v118, v118, v8
    v_mul_f32 v119, v119, v8
    v_cvt_pk_bf16_f32 v60, v112, v113
    v_cvt_pk_bf16_f32 v61, v114, v115
    v_cvt_pk_bf16_f32 v62, v116, v117
    v_cvt_pk_bf16_f32 v63, v118, v119
    buffer_store_dwordx4 v[60:63], v26, s[24:27], s10 offen offset:1024 sc1
    s_lshl_b32 s9, s3, 2
    v_mov_b32 v11, s9
    s_mov_b32 s71, 0
L_r2w:
    ds_read_b32 v10, v11 offset:12304
    s_waitcnt lgkmcnt(0)
    v_readfirstlane_b32 s9, v10
    s_add_u32 s71, s71, 1
    s_cmp_gt_u32 s71, 480000
    s_cbranch_scc1 L_r2wx
    s_cmp_eq_u32 s9, s75
    s_cbranch_scc1 L_r2wx
    s_sleep 1
    s_branch L_r2w
L_r2wx:
L_tailB:
    v_mov_b32 v2, v12
    v_mov_b32 v3, v13
    v_mov_b32 v4, v14
    v_mov_b32 v5, v15
    v_mov_b32 v6, v16
    v_mov_b32 v7, v17
L_tail:
    s_mul_i32 s64, s82, 294912
    s_mul_i32 s65, s3, 14336
    s_add_u32 s65, s65, s64
    s_lshl_b32 s66, s3, 12
    s_add_u32 s66, s66, s64
    s_add_u32 s66, s66, 114688
    s_add_u32 s67, s66, 147456
    s_lshl_b32 s9, s82, 8
    s_add_u32 s72, s9, 9515008
    s_add_u32 s73, s9, 9523200
    v_lshlrev_b32 v0, 4, v1
    v_lshlrev_b32 v8, 2, v1
    s_cmp_eq_u32 s3, 0
    s_cbranch_scc0 L_phok
    s_mov_b32 s79, 0
L_ph:
    buffer_load_dword v10, v8, s[24:27], s72 offen sc1
    s_waitcnt vmcnt(0)
    v_cmp_ne_u32 vcc, s75, v10
    s_cmp_eq_u64 vcc, 0
    s_cbranch_scc1 L_phok
    s_add_u32 s79, s79, 1
    s_cmp_gt_u32 s79, 60000
    s_cbranch_scc1 L_phok
    s_sleep 8
    s_branch L_ph
L_phok:
    s_barrier
    s_mov_b32 s60, s65
    s_add_u32 s83, s65, 14336
    s_lshl_b32 s9, s76, 10
    s_add_u32 s65, s65, s9
    s_add_u32 s71, s65, 147456
    buffer_load_dwordx4 v[200:203], v0, s[24:27], s65 offen sc1
    buffer_load_dwordx4 v[204:207], v0, s[24:27], s71 offen sc1
    s_add_u32 s65, s65, 1024
    s_cmp_eq_u32 s65, s83
    s_cselect_b32 s65, s60, s65
    s_add_u32 s71, s65, 147456
    buffer_load_dwordx4 v[208:211], v0, s[24:27], s65 offen sc1
    buffer_load_dwordx4 v[212:215], v0, s[24:27], s71 offen sc1
    s_add_u32 s65, s65, 1024
    s_cmp_eq_u32 s65, s83
    s_cselect_b32 s65, s60, s65
    s_add_u32 s71, s65, 147456
    buffer_load_dwordx4 v[216:219], v0, s[24:27], s65 offen sc1
    buffer_load_dwordx4 v[220:223], v0, s[24:27], s71 offen sc1
    s_add_u32 s65, s65, 1024
    s_cmp_eq_u32 s65, s83
    s_cselect_b32 s65, s60, s65
    s_add_u32 s71, s65, 147456
    buffer_load_dwordx4 v[224:227], v0, s[24:27], s65 offen sc1
    buffer_load_dwordx4 v[228:231], v0, s[24:27], s71 offen sc1
    s_add_u32 s65, s65, 1024
    s_cmp_eq_u32 s65, s83
    s_cselect_b32 s65, s60, s65
    s_add_u32 s71, s65, 147456
    buffer_load_dwordx4 v[232:235], v0, s[24:27], s65 offen sc1
    buffer_load_dwordx4 v[236:239], v0, s[24:27], s71 offen sc1
    s_add_u32 s65, s65, 1024
    s_cmp_eq_u32 s65, s83
    s_cselect_b32 s65, s60, s65
    s_add_u32 s71, s65, 147456
    buffer_load_dwordx4 v[240:243], v0, s[24:27], s65 offen sc1
    buffer_load_dwordx4 v[244:247], v0, s[24:27], s71 offen sc1
    s_add_u32 s65, s65, 1024
    s_cmp_eq_u32 s65, s83
    s_cselect_b32 s65, s60, s65
    s_add_u32 s71, s65, 147456
    buffer_load_dwordx4 v[248:251], v0, s[24:27], s65 offen sc1
    buffer_load_dwordx4 v[252:255], v0, s[24:27], s71 offen sc1
    s_add_u32 s65, s65, 1024
    s_cmp_eq_u32 s65, s83
    s_cselect_b32 s65, s60, s65
    s_add_u32 s71, s65, 147456
    buffer_load_dwordx4 v[16:19], v0, s[24:27], s65 offen sc1
    buffer_load_dwordx4 v[20:23], v0, s[24:27], s71 offen sc1
    s_add_u32 s65, s65, 1024
    s_cmp_eq_u32 s65, s83
    s_cselect_b32 s65, s60, s65
    s_add_u32 s71, s65, 147456
    buffer_load_dwordx4 v[24:27], v0, s[24:27], s65 offen sc1
    buffer_load_dwordx4 v[28:31], v0, s[24:27], s71 offen sc1
    s_add_u32 s65, s65, 1024
    s_cmp_eq_u32 s65, s83
    s_cselect_b32 s65, s60, s65
    s_add_u32 s71, s65, 147456
    buffer_load_dwordx4 v[32:35], v0, s[24:27], s65 offen sc1
    buffer_load_dwordx4 v[36:39], v0, s[24:27], s71 offen sc1
    s_add_u32 s65, s65, 1024
    s_cmp_eq_u32 s65, s83
    s_cselect_b32 s65, s60, s65
    s_add_u32 s71, s65, 147456
    buffer_load_dwordx4 v[40:43], v0, s[24:27], s65 offen sc1
    buffer_load_dwordx4 v[44:47], v0, s[24:27], s71 offen sc1
    s_add_u32 s65, s65, 1024
    s_cmp_eq_u32 s65, s83
    s_cselect_b32 s65, s60, s65
    v_lshrrev_b32 v12, 3, v1
    v_lshlrev_b32 v12, 10, v12
    v_and_b32 v13, 7, v1
    v_lshlrev_b32 v13, 4, v13
    v_add_u32 v12, v12, v13
    s_lshl_b32 s74, s82, 16
    s_lshl_b32 s9, s3, 13
    s_add_u32 s74, s74, s9
    s_add_u32 s74, s74, s62
    s_waitcnt vmcnt(20)
    v_mfma_f32_32x32x16_bf16 v[64:79], v[128:131], v[200:203], 0
    v_mfma_f32_32x32x16_bf16 v[80:95], v[132:135], v[200:203], 0
    v_mfma_f32_32x32x16_bf16 v[96:111], v[128:131], v[204:207], 0
    v_mfma_f32_32x32x16_bf16 v[112:127], v[132:135], v[204:207], 0
    s_add_u32 s71, s65, 147456
    buffer_load_dwordx4 v[200:203], v0, s[24:27], s65 offen sc1
    buffer_load_dwordx4 v[204:207], v0, s[24:27], s71 offen sc1
    s_add_u32 s65, s65, 1024
    s_cmp_eq_u32 s65, s83
    s_cselect_b32 s65, s60, s65
    s_waitcnt vmcnt(20)
    v_mfma_f32_32x32x16_bf16 v[64:79], v[136:139], v[208:211], v[64:79]
    v_mfma_f32_32x32x16_bf16 v[80:95], v[140:143], v[208:211], v[80:95]
    v_mfma_f32_32x32x16_bf16 v[96:111], v[136:139], v[212:215], v[96:111]
    v_mfma_f32_32x32x16_bf16 v[112:127], v[140:143], v[212:215], v[112:127]
    s_add_u32 s71, s65, 147456
    buffer_load_dwordx4 v[208:211], v0, s[24:27], s65 offen sc1
    buffer_load_dwordx4 v[212:215], v0, s[24:27], s71 offen sc1
    s_add_u32 s65, s65, 1024
    s_cmp_eq_u32 s65, s83
    s_cselect_b32 s65, s60, s65
    s_waitcnt vmcnt(20)
    v_mfma_f32_32x32x16_bf16 v[64:79], v[144:147], v[216:219], v[64:79]
    v_mfma_f32_32x32x16_bf16 v[80:95], v[148:151], v[216:219], v[80:95]
    v_mfma_f32_32x32x16_bf16 v[96:111], v[144:147], v[220:223], v[96:111]
    v_mfma_f32_32x32x16_bf16 v[112:127], v[148:151], v[220:223], v[112:127]
    s_add_u32 s71, s65, 147456
    buffer_load_dwordx4 v[216:219], v0, s[24:27], s65 offen sc1
    buffer_load_dwordx4 v[220:223], v0, s[24:27], s71 offen sc1
    s_add_u32 s65, s65, 1024
    s_cmp_eq_u32 s65, s83
    s_cselect_b32 s65, s60, s65
    s_waitcnt vmcnt(20)
    v_mfma_f32_32x32x16_bf16 v[64:79], v[152:155], v[224:227], v[64:79]
    v_mfma_f32_32x32x16_bf16 v[80:95], v[156:159], v[224:227], v[80:95]
    v_mfma_f32_32x32x16_bf16 v[96:111], v[152:155], v[228:231], v[96:111]
    v_mfma_f32_32x32x16_bf16 v[112:127], v[156:159], v[228:231], v[112:127]
    buffer_load_dwordx4 v[128:131], v12, s[12:15], s74 offen
    buffer_load_dwordx4 v[132:135], v13, s[52:55], s62 offen
    s_waitcnt vmcnt(20)
    v_mfma_f32_32x32x16_bf16 v[64:79], v[160:163], v[232:235], v[64:79]
    v_mfma_f32_32x32x16_bf16 v[80:95], v[164:167], v[232:235], v[80:95]
    v_mfma_f32_32x32x16_bf16 v[96:111], v[160:163], v[236:239], v[96:111]
    v_mfma_f32_32x32x16_bf16 v[112:127], v[164:167], v[236:239], v[112:127]
    s_waitcnt vmcnt(18)
    v_mfma_f32_32x32x16_bf16 v[64:79], v[168:171], v[240:243], v[64:79]
    v_mfma_f32_32x32x16_bf16 v[80:95], v[172:175], v[240:243], v[80:95]
    v_mfma_f32_32x32x16_bf16 v[96:111], v[168:171], v[244:247], v[96:111]
    v_mfma_f32_32x32x16_bf16 v[112:127], v[172:175], v[244:247], v[112:127]
    s_waitcnt vmcnt(16)
    v_mfma_f32_32x32x16_bf16 v[64:79], v[176:179], v[248:251], v[64:79]
    v_mfma_f32_32x32x16_bf16 v[80:95], v[180:183], v[248:251], v[80:95]
    v_mfma_f32_32x32x16_bf16 v[96:111], v[176:179], v[252:255], v[96:111]
    v_mfma_f32_32x32x16_bf16 v[112:127], v[180:183], v[252:255], v[112:127]
    buffer_load_dwordx4 v[224:227], v0, s[24:27], s66 offen offset:0 sc1
    buffer_load_dwordx4 v[228:231], v0, s[24:27], s67 offen offset:0 sc1
    buffer_load_dwordx4 v[232:235], v0, s[24:27], s66 offen offset:1024 sc1
    buffer_load_dwordx4 v[236:239], v0, s[24:27], s67 offen offset:1024 sc1
    buffer_load_dwordx4 v[240:243], v0, s[24:27], s66 offen offset:2048 sc1
    buffer_load_dwordx4 v[244:247], v0, s[24:27], s67 offen offset:2048 sc1
    buffer_load_dwordx4 v[248:251], v0, s[24:27], s66 offen offset:3072 sc1
    buffer_load_dwordx4 v[252:255], v0, s[24:27], s67 offen offset:3072 sc1
    s_waitcnt vmcnt(22)
    v_mfma_f32_32x32x16_bf16 v[64:79], v[184:187], v[16:19], v[64:79]
    v_mfma_f32_32x32x16_bf16 v[80:95], v[188:191], v[16:19], v[80:95]
    v_mfma_f32_32x32x16_bf16 v[96:111], v[184:187], v[20:23], v[96:111]
    v_mfma_f32_32x32x16_bf16 v[112:127], v[188:191], v[20:23], v[112:127]
    ds_read_b64_tr_b16 v[48:49], v4 offset:49152
    ds_read_b64_tr_b16 v[50:51], v4 offset:50176
    ds_read_b64_tr_b16 v[52:53], v5 offset:49152
    ds_read_b64_tr_b16 v[54:55], v5 offset:50176
    s_waitcnt vmcnt(20)
    v_mfma_f32_32x32x16_bf16 v[64:79], v[192:195], v[24:27], v[64:79]
    v_mfma_f32_32x32x16_bf16 v[80:95], v[196:199], v[24:27], v[80:95]
    v_mfma_f32_32x32x16_bf16 v[96:111], v[192:195], v[28:31], v[96:111]
    v_mfma_f32_32x32x16_bf16 v[112:127], v[196:199], v[28:31], v[112:127]
    ds_read_b64_tr_b16 v[56:57], v6 offset:0
    ds_read_b64_tr_b16 v[58:59], v6 offset:1024
    ds_read_b64_tr_b16 v[60:61], v7 offset:0
    ds_read_b64_tr_b16 v[62:63], v7 offset:1024
    s_waitcnt lgkmcnt(4)
    s_waitcnt vmcnt(18)
    v_mfma_f32_32x32x16_bf16 v[64:79], v[48:51], v[32:35], v[64:79]
    v_mfma_f32_32x32x16_bf16 v[80:95], v[52:55], v[32:35], v[80:95]
    v_mfma_f32_32x32x16_bf16 v[96:111], v[48:51], v[36:39], v[96:111]
    v_mfma_f32_32x32x16_bf16 v[112:127], v[52:55], v[36:39], v[112:127]
    ds_read_b64_tr_b16 v[48:49], v6 offset:16384
    ds_read_b64_tr_b16 v[50:51], v6 offset:17408
    ds_read_b64_tr_b16 v[52:53], v7 offset:16384
    ds_read_b64_tr_b16 v[54:55], v7 offset:17408
    s_waitcnt lgkmcnt(4)
    s_waitcnt vmcnt(16)
    v_mfma_f32_32x32x16_bf16 v[64:79], v[56:59], v[40:43], v[64:79]
    v_mfma_f32_32x32x16_bf16 v[80:95], v[60:63], v[40:43], v[80:95]
    v_mfma_f32_32x32x16_bf16 v[96:111], v[56:59], v[44:47], v[96:111]
    v_mfma_f32_32x32x16_bf16 v[112:127], v[60:63], v[44:47], v[112:127]
    ds_read_b64_tr_b16 v[56:57], v2 offset:16384
    ds_read_b64_tr_b16 v[58:59], v2 offset:17408
    ds_read_b64_tr_b16 v[60:61], v3 offset:16384
    ds_read_b64_tr_b16 v[62:63], v3 offset:17408
    s_waitcnt lgkmcnt(4)
    s_waitcnt vmcnt(14)
    v_mfma_f32_32x32x16_bf16 v[64:79], v[48:51], v[200:203], v[64:79]
    v_mfma_f32_32x32x16_bf16 v[80:95], v[52:55], v[200:203], v[80:95]
    v_mfma_f32_32x32x16_bf16 v[96:111], v[48:51], v[204:207], v[96:111]
    v_mfma_f32_32x32x16_bf16 v[112:127], v[52:55], v[204:207], v[112:127]
    ds_read_b64_tr_b16 v[48:49], v2 offset:32768
    ds_read_b64_tr_b16 v[50:51], v2 offset:33792
    ds_read_b64_tr_b16 v[52:53], v3 offset:32768
    ds_read_b64_tr_b16 v[54:55], v3 offset:33792
    s_waitcnt lgkmcnt(4)
    s_waitcnt vmcnt(12)
    v_mfma_f32_32x32x16_bf16 v[64:79], v[56:59], v[208:211], v[64:79]
    v_mfma_f32_32x32x16_bf16 v[80:95], v[60:63], v[208:211], v[80:95]
    v_mfma_f32_32x32x16_bf16 v[96:111], v[56:59], v[212:215], v[96:111]
    v_mfma_f32_32x32x16_bf16 v[112:127], v[60:63], v[212:215], v[112:127]
    ds_read_b64_tr_b16 v[56:57], v2 offset:49152
    ds_read_b64_tr_b16 v[58:59], v2 offset:50176
    ds_read_b64_tr_b16 v[60:61], v3 offset:49152
    ds_read_b64_tr_b16 v[62:63], v3 offset:50176
    s_waitcnt lgkmcnt(4)
    s_waitcnt vmcnt(10)
    v_mfma_f32_32x32x16_bf16 v[64:79], v[48:51], v[216:219], v[64:79]
    v_mfma_f32_32x32x16_bf16 v[80:95], v[52:55], v[216:219], v[80:95]
    v_mfma_f32_32x32x16_bf16 v[96:111], v[48:51], v[220:223], v[96:111]
    v_mfma_f32_32x32x16_bf16 v[112:127], v[52:55], v[220:223], v[112:127]
    ds_read_b64_tr_b16 v[48:49], v4 offset:0
    ds_read_b64_tr_b16 v[50:51], v4 offset:1024
    ds_read_b64_tr_b16 v[52:53], v5 offset:0
    ds_read_b64_tr_b16 v[54:55], v5 offset:1024
    s_waitcnt lgkmcnt(4)
    s_waitcnt vmcnt(6)
    s_mov_b32 s79, 0
L_oc14:
    v_cmp_eq_u32 vcc, -1, v224
    v_cmp_eq_u32 s[80:81], -1, v228
    s_or_b64 vcc, vcc, s[80:81]
    s_cmp_eq_u64 vcc, 0
    s_cbranch_scc1 L_ok14
    s_add_u32 s79, s79, 1
    s_cmp_gt_u32 s79, 60000
    s_cbranch_scc1 L_ok14
    s_sleep 8
    buffer_load_dwordx4 v[224:227], v0, s[24:27], s66 offen offset:0 sc1
    buffer_load_dwordx4 v[228:231], v0, s[24:27], s67 offen offset:0 sc1
    s_waitcnt vmcnt(0)
    s_branch L_oc14
L_ok14:
    v_mfma_f32_32x32x16_bf16 v[64:79], v[56:59], v[224:227], v[64:79]
    v_mfma_f32_32x32x16_bf16 v[80:95], v[60:63], v[224:227], v[80:95]
    v_mfma_f32_32x32x16_bf16 v[96:111], v[56:59], v[228:231], v[96:111]
    v_mfma_f32_32x32x16_bf16 v[112:127], v[60:63], v[228:231], v[112:127]
    ds_read_b64_tr_b16 v[56:57], v4 offset:16384
    ds_read_b64_tr_b16 v[58:59], v4 offset:17408
    ds_read_b64_tr_b16 v[60:61], v5 offset:16384
    ds_read_b64_tr_b16 v[62:63], v5 offset:17408
    s_waitcnt lgkmcnt(4)
    s_waitcnt vmcnt(4)
    s_mov_b32 s79, 0
L_oc15:
    v_cmp_eq_u32 vcc, -1, v232
    v_cmp_eq_u32 s[80:81], -1, v236
    s_or_b64 vcc, vcc, s[80:81]
    s_cmp_eq_u64 vcc, 0
    s_cbranch_scc1 L_ok15
    s_add_u32 s79, s79, 1
    s_cmp_gt_u32 s79, 60000
    s_cbranch_scc1 L_ok15
    s_sleep 8
    buffer_load_dwordx4 v[232:235], v0, s[24:27], s66 offen offset:1024 sc1
    buffer_load_dwordx4 v[236:239], v0, s[24:27], s67 offen offset:1024 sc1
    s_waitcnt vmcnt(0)
    s_branch L_oc15
L_ok15:
    v_mfma_f32_32x32x16_bf16 v[64:79], v[48:51], v[232:235], v[64:79]
    v_mfma_f32_32x32x16_bf16 v[80:95], v[52:55], v[232:235], v[80:95]
    v_mfma_f32_32x32x16_bf16 v[96:111], v[48:51], v[236:239], v[96:111]
    v_mfma_f32_32x32x16_bf16 v[112:127], v[52:55], v[236:239], v[112:127]
    s_or_b32 s9, s2, s3
    s_cmp_eq_u32 s9, 0
    s_cbranch_scc0 L_noclr1
    v_mov_b32 v8, 0
    s_mov_b64 exec, 1
    buffer_store_dword v8, v8, s[28:31], 0 offen sc1
    s_mov_b64 exec, -1
L_noclr1:
    ds_read_b64_tr_b16 v[48:49], v4 offset:32768
    ds_read_b64_tr_b16 v[50:51], v4 offset:33792
    ds_read_b64_tr_b16 v[52:53], v5 offset:32768
    ds_read_b64_tr_b16 v[54:55], v5 offset:33792
    s_waitcnt lgkmcnt(4)
    s_waitcnt vmcnt(2)
    s_mov_b32 s79, 0
L_oc16:
    v_cmp_eq_u32 vcc, -1, v240
    v_cmp_eq_u32 s[80:81], -1, v244
    s_or_b64 vcc, vcc, s[80:81]
    s_cmp_eq_u64 vcc, 0
    s_cbranch_scc1 L_ok16
    s_add_u32 s79, s79, 1
    s_cmp_gt_u32 s79, 60000
    s_cbranch_scc1 L_ok16
    s_sleep 8
    buffer_load_dwordx4 v[240:243], v0, s[24:27], s66 offen offset:2048 sc1
    buffer_load_dwordx4 v[244:247], v0, s[24:27], s67 offen offset:2048 sc1
    s_waitcnt vmcnt(0)
    s_branch L_oc16
L_ok16:
    v_mfma_f32_32x32x16_bf16 v[64:79], v[56:59], v[240:243], v[64:79]
    v_mfma_f32_32x32x16_bf16 v[80:95], v[60:63], v[240:243], v[80:95]
    v_mfma_f32_32x32x16_bf16 v[96:111], v[56:59], v[244:247], v[96:111]
    v_mfma_f32_32x32x16_bf16 v[112:127], v[60:63], v[244:247], v[112:127]
    s_waitcnt lgkmcnt(0)
    s_waitcnt vmcnt(0)
    s_mov_b32 s79, 0
L_oc17:
    v_cmp_eq_u32 vcc, -1, v248
    v_cmp_eq_u32 s[80:81], -1, v252
    s_or_b64 vcc, vcc, s[80:81]
    s_cmp_eq_u64 vcc, 0
    s_cbranch_scc1 L_ok17
    s_add_u32 s79, s79, 1
    s_cmp_gt_u32 s79, 60000
    s_cbranch_scc1 L_ok17
    s_sleep 8
    buffer_load_dwordx4 v[248:251], v0, s[24:27], s66 offen offset:3072 sc1
    buffer_load_dwordx4 v[252:255], v0, s[24:27], s67 offen offset:3072 sc1
    s_waitcnt vmcnt(0)
    s_branch L_oc17
L_ok17:
    v_mfma_f32_32x32x16_bf16 v[64:79], v[48:51], v[248:251], v[64:79]
    v_mfma_f32_32x32x16_bf16 v[80:95], v[52:55], v[248:251], v[80:95]
    v_mfma_f32_32x32x16_bf16 v[96:111], v[48:51], v[252:255], v[96:111]
    v_mfma_f32_32x32x16_bf16 v[112:127], v[52:55], v[252:255], v[112:127]
    v_bfe_u32 v8, v1, 3, 2
    v_lshlrev_b32 v8, 14, v8
    v_and_b32 v9, 7, v1
    v_lshl_add_u32 v8, v9, 8, v8
    v_lshrrev_b32 v10, 5, v1
    v_xor_b32 v10, v10, v9
    v_lshl_add_u32 v8, v10, 4, v8
    s_add_u32 s9, s69, 16384
    v_add_u32 v8, s9, v8
    v_xor_b32 v9, 32, v8
    v_xor_b32 v10, 64, v8
    v_xor_b32 v11, 96, v8
    v_add_u32 v2, 0x10000, v8
    v_add_u32 v3, 0x10000, v9
    v_add_u32 v4, 0x10000, v10
    v_add_u32 v5, 0x10000, v11
    ds_write_b128 v8, v[64:67] offset:0
    ds_write_b128 v9, v[68:71] offset:0
    ds_write_b128 v10, v[72:75] offset:0
    ds_write_b128 v11, v[76:79] offset:0
    ds_write_b128 v8, v[80:83] offset:128
    ds_write_b128 v9, v[84:87] offset:128
    ds_write_b128 v10, v[88:91] offset:128
    ds_write_b128 v11, v[92:95] offset:128
    ds_write_b128 v2, v[96:99] offset:0
    ds_write_b128 v3, v[100:103] offset:0
    ds_write_b128 v4, v[104:107] offset:0
    ds_write_b128 v5, v[108:111] offset:0
    ds_write_b128 v2, v[112:115] offset:128
    ds_write_b128 v3, v[116:119] offset:128
    ds_write_b128 v4, v[120:123] offset:128
    ds_write_b128 v5, v[124:127] offset:128
    v_lshrrev_b32 v6, 3, v1
    v_and_b32 v7, 7, v1
    v_lshlrev_b32 v7, 1, v7
    v_xor_b32 v7, v7, v6
    v_lshlrev_b32 v6, 8, v6
    v_lshl_add_u32 v6, v7, 4, v6
    s_lshl_b32 s9, s3, 14
    s_add_u32 s9, s9, 16384
    v_add_u32 v6, s9, v6
    v_xor_b32 v7, 16, v6
    s_waitcnt lgkmcnt(0)
    s_barrier
    ds_read_b128 v[160:163], v6 offset:0
    ds_read_b128 v[164:167], v7 offset:0
    ds_read_b128 v[168:171], v6 offset:2048
    ds_read_b128 v[172:175], v7 offset:2048
    ds_read_b128 v[176:179], v6 offset:4096
    ds_read_b128 v[180:183], v7 offset:4096
    ds_read_b128 v[184:187], v6 offset:6144
    ds_read_b128 v[188:191], v7 offset:6144
    ds_read_b128 v[192:195], v6 offset:8192
    ds_read_b128 v[196:199], v7 offset:8192
    ds_read_b128 v[200:203], v6 offset:10240
    ds_read_b128 v[204:207], v7 offset:10240
    ds_read_b128 v[208:211], v6 offset:12288
    ds_read_b128 v[212:215], v7 offset:12288
    ds_read_b128 v[216:219], v6 offset:14336
    ds_read_b128 v[220:223], v7 offset:14336
    v_lshlrev_b32 v24, 16, v128
    v_and_b32 v25, 0xffff0000, v128
    v_lshlrev_b32 v32, 16, v132
    v_and_b32 v33, 0xffff0000, v132
    v_lshlrev_b32 v26, 16, v129
    v_and_b32 v27, 0xffff0000, v129
    v_lshlrev_b32 v34, 16, v133
    v_and_b32 v35, 0xffff0000, v133
    v_lshlrev_b32 v28, 16, v130
    v_and_b32 v29, 0xffff0000, v130
    v_lshlrev_b32 v36, 16, v134
    v_and_b32 v37, 0xffff0000, v134
    v_lshlrev_b32 v30, 16, v131
    v_and_b32 v31, 0xffff0000, v131
    v_lshlrev_b32 v38, 16, v135
    v_and_b32 v39, 0xffff0000, v135
    v_add_f32 v24, v24, v32
    v_add_f32 v25, v25, v33
    v_add_f32 v26, v26, v34
    v_add_f32 v27, v27, v35
    v_add_f32 v28, v28, v36
    v_add_f32 v29, v29, v37
    v_add_f32 v30, v30, v38
    v_add_f32 v31, v31, v39
    s_waitcnt lgkmcnt(14)
    v_add_f32 v24, v24, v160
    v_add_f32 v25, v25, v161
    v_add_f32 v26, v26, v162
    v_add_f32 v27, v27, v163
    v_add_f32 v28, v28, v164
    v_add_f32 v29, v29, v165
    v_add_f32 v30, v30, v166
    v_add_f32 v31, v31, v167
    s_waitcnt lgkmcnt(12)
    v_add_f32 v24, v24, v168
    v_add_f32 v25, v25, v169
    v_add_f32 v26, v26, v170
    v_add_f32 v27, v27, v171
    v_add_f32 v28, v28, v172
    v_add_f32 v29, v29, v173
    v_add_f32 v30, v30, v174
    v_add_f32 v31, v31, v175
    s_waitcnt lgkmcnt(10)
    v_add_f32 v24, v24, v176
    v_add_f32 v25, v25, v177
    v_add_f32 v26, v26, v178
    v_add_f32 v27, v27, v179
    v_add_f32 v28, v28, v180
    v_add_f32 v29, v29, v181
    v_add_f32 v30, v30, v182
    v_add_f32 v31, v31, v183
    s_waitcnt lgkmcnt(8)
    v_add_f32 v24, v24, v184
    v_add_f32 v25, v25, v185
    v_add_f32 v26, v26, v186
    v_add_f32 v27, v27, v187
    v_add_f32 v28, v28, v188
    v_add_f32 v29, v29, v189
    v_add_f32 v30, v30, v190
    v_add_f32 v31, v31, v191
    s_waitcnt lgkmcnt(6)
    v_add_f32 v24, v24, v192
    v_add_f32 v25, v25, v193
    v_add_f32 v26, v26, v194
    v_add_f32 v27, v27, v195
    v_add_f32 v28, v28, v196
    v_add_f32 v29, v29, v197
    v_add_f32 v30, v30, v198
    v_add_f32 v31, v31, v199
    s_waitcnt lgkmcnt(4)
    v_add_f32 v24, v24, v200
    v_add_f32 v25, v25, v201
    v_add_f32 v26, v26, v202
    v_add_f32 v27, v27, v203
    v_add_f32 v28, v28, v204
    v_add_f32 v29, v29, v205
    v_add_f32 v30, v30, v206
    v_add_f32 v31, v31, v207
    s_waitcnt lgkmcnt(2)
    v_add_f32 v24, v24, v208
    v_add_f32 v25, v25, v209
    v_add_f32 v26, v26, v210
    v_add_f32 v27, v27, v211
    v_add_f32 v28, v28, v212
    v_add_f32 v29, v29, v213
    v_add_f32 v30, v30, v214
    v_add_f32 v31, v31, v215
    s_waitcnt lgkmcnt(0)
    v_add_f32 v24, v24, v216
    v_add_f32 v25, v25, v217
    v_add_f32 v26, v26, v218
    v_add_f32 v27, v27, v219
    v_add_f32 v28, v28, v220
    v_add_f32 v29, v29, v221
    v_add_f32 v30, v30, v222
    v_add_f32 v31, v31, v223
    v_cvt_pk_bf16_f32 v32, v24, v25
    v_cvt_pk_bf16_f32 v33, v26, v27
    v_cvt_pk_bf16_f32 v34, v28, v29
    v_cvt_pk_bf16_f32 v35, v30, v31
    buffer_store_dwordx4 v[32:35], v12, s[56:59], s74 offen
L_end:
    s_endpgm
.section .rodata,"a"
.p2align 6
.amdhsa_kernel parallel_sum__linear_kernel_hedgehog__dense_activation_squared_relu__prompt_kernel
  .amdhsa_next_free_vgpr 256
  .amdhsa_next_free_sgpr 102
  .amdhsa_accum_offset 256
  .amdhsa_group_segment_fixed_size 0
  .amdhsa_kernarg_size 96
  .amdhsa_user_sgpr_count 2
  .amdhsa_user_sgpr_kernarg_segment_ptr 1
  .amdhsa_system_sgpr_workgroup_id_x 1
  .amdhsa_float_denorm_mode_32 3
.end_amdhsa_kernel
```
